```python
import torch

def _softmax(x, axis=-1):
    return torch.softmax(x, dim=axis)
def _gelu(x):
    return torch.nn.functional.gelu(x, approximate="tanh")
def _silu(x):
    return torch.nn.functional.silu(x)
def _sigmoid(x):
    return torch.sigmoid(x)
def _layernorm(x, axis=-1, eps=1e-5):
    m = x.mean(dim=axis, keepdim=True)
    v = x.var(dim=axis, keepdim=True, unbiased=False)
    return (x - m) / torch.sqrt(v + eps)
def _scatter_add(tgt, idx, src, axis=0):
    return tgt.clone().index_add_(axis, idx, src)
def _segment_sum(src, seg, n):
    out = torch.zeros((n,) + src.shape[1:], dtype=src.dtype)
    return out.index_add_(0, seg, src)
def _pad(x, pw):
    flat = tuple(v for pair in reversed(pw) for v in pair)
    return torch.nn.functional.pad(x, flat)

kernel_name = 'standalone__mha_block_cached__near_ridge'

def setup_inputs():

    _w = (lambda a: (lambda t: t.to(torch.bfloat16) if t.is_floating_point() else t)(torch.as_tensor(a)))
    B, Sq, D = 16, 192, 512
    H, Sk, Dh = 32, 512, 128
    return {
        "x": _w((lambda *s: torch.randn(*s, dtype=torch.bfloat16) * 0.8)(B, Sq, D)),
        "k_cache": _w((lambda *s: torch.randn(*s, dtype=torch.bfloat16) * 0.8)(B, H, Sk, Dh)),
        "v_cache": _w((lambda *s: torch.randn(*s, dtype=torch.bfloat16) * 0.05)(B, H, Sk, Dh)),
        "wq": _w((lambda *s: torch.randn(*s, dtype=torch.bfloat16) * 0.8)(D, H * Dh) * (D ** -0.5)),
        "wo": _w((lambda *s: torch.randn(*s, dtype=torch.bfloat16) * 0.05)(H * Dh, D) * ((H * Dh) ** -0.5)),
    }

def reference(x, k_cache, v_cache, wq, wo):
    B, Sq, D = x.shape
    H, Dh = 32, 128
    q = (lambda x, *d: x.permute(*d))((x @ wq).reshape(B, Sq, H, Dh), 0, 2, 1, 3)
    scores = torch.einsum("bhqd,bhkd->bhqk", q, k_cache) * (Dh ** -0.5)
    p = _softmax(scores, axis=-1)
    o = torch.einsum("bhqk,bhkd->bhqd", p, v_cache)
    return (lambda x, *d: x.permute(*d))(o, 0, 2, 1, 3).reshape(B, Sq, H * Dh) @ wo
```

```asm
; @launch grid=(256,1,1) block=(768,1,1) lds=163840
.amdgcn_target "amdgcn-amd-amdhsa--gfx950"
.text
    .globl standalone__mha_block_cached__near_ridge_kernel
    .p2align 8
    .type standalone__mha_block_cached__near_ridge_kernel,@function
standalone__mha_block_cached__near_ridge_kernel:
    s_cmp_ge_u32 s2, 256
    s_cbranch_scc1 standalone__mha_block_cached__near_ridge_kernel_end
    s_load_dwordx4 s[48:51], s[0:1], 0
    s_load_dwordx4 s[52:55], s[0:1], 16
    s_load_dwordx4 s[92:95], s[0:1], 32
    s_load_dwordx4 s[96:99], s[0:1], 48
    v_lshrrev_b32 v3, 6, v0
    v_and_b32 v7, 63, v0
    v_readfirstlane_b32 s28, v3
    s_and_b32 s42, s2, 7
    s_lshr_b32 s31, s2, 7
    s_lshl_b32 s43, s42, 1
    s_add_u32 s31, s31, s43
    s_lshr_b32 s40, s42, 2
    s_lshl_b32 s40, s40, 3
    s_lshr_b32 s43, s2, 5
    s_add_u32 s40, s40, s43
    s_and_b32 s41, s42, 3
    s_lshl_b32 s41, s41, 2
    s_bfe_u32 s43, s2, 0x20003
    s_add_u32 s41, s41, s43
    s_cmp_ge_u32 s28, 6
    s_cselect_b32 s29, 1, 0
    s_mul_i32 s42, s29, 6
    s_sub_u32 s30, s28, s42
    s_and_b32 s42, s28, 1
    s_lshl_b32 s43, s42, 2
    v_lshrrev_b32 v3, 4, v7
    v_add_u32 v3, s43, v3
    v_and_b32 v4, 7, v7
    v_xor_b32 v3, v3, v4
    v_lshlrev_b32 v3, 4, v3
    v_lshrrev_b32 v4, 3, v7
    v_lshlrev_b32 v4, 10, v4
    s_lshl_b32 s43, s28, 13
    v_add3_u32 v120, v3, v4, s43
    s_lshl_b32 s43, s42, 1
    v_lshrrev_b32 v3, 5, v7
    v_add_u32 v4, s43, v3
    v_lshlrev_b32 v4, 2, v4
    v_and_b32 v121, 31, v7
    v_xor_b32 v4, v4, v121
    v_lshlrev_b32 v4, 4, v4
    v_lshlrev_b32 v3, 13, v3
    s_lshl_b32 s43, s28, 14
    v_add3_u32 v121, v3, v4, s43
    s_lshl_b32 s37, s28, 10
    s_waitcnt lgkmcnt(0)
    s_lshl_b32 s42, s41, 9
    s_add_u32 s12, s54, s42
    s_addc_u32 s13, s55, 0
    s_mov_b32 s14, 4194304
    s_mov_b32 s15, 0x00020000
    s_sub_u32 s14, s14, s42
    s_mul_i32 s42, s40, 196608
    s_add_u32 s8, s48, s42
    s_addc_u32 s9, s49, 0
    s_mov_b32 s10, 196608
    s_mov_b32 s11, 0x00020000
    s_cmp_ge_u32 s28, 4
    s_cbranch_scc1 ld_1
    s_add_u32 m0, s37, 98304
    s_mov_b32 s36, 0
    buffer_load_dwordx4 v121, s[12:15], s36 offen lds
    s_add_u32 m0, s37, 102400
    s_mov_b32 s36, 65536
    buffer_load_dwordx4 v121, s[12:15], s36 offen lds
    s_add_u32 m0, s37, 106496
    s_mov_b32 s36, 131072
    buffer_load_dwordx4 v121, s[12:15], s36 offen lds
    s_add_u32 m0, s37, 110592
    s_mov_b32 s36, 196608
    buffer_load_dwordx4 v121, s[12:15], s36 offen lds
    s_add_u32 m0, s37, 73728
    s_mov_b32 s36, 0
    buffer_load_dwordx4 v120, s[8:11], s36 offen lds
    s_add_u32 m0, s37, 77824
    s_mov_b32 s36, 32768
    buffer_load_dwordx4 v120, s[8:11], s36 offen lds
    s_add_u32 m0, s37, 81920
    s_mov_b32 s36, 65536
    buffer_load_dwordx4 v120, s[8:11], s36 offen lds
    s_add_u32 m0, s37, 86016
    s_mov_b32 s36, 98304
    buffer_load_dwordx4 v120, s[8:11], s36 offen lds
    s_add_u32 m0, s37, 90112
    s_mov_b32 s36, 131072
    buffer_load_dwordx4 v120, s[8:11], s36 offen lds
    s_add_u32 m0, s37, 94208
    s_mov_b32 s36, 163840
    buffer_load_dwordx4 v120, s[8:11], s36 offen lds
    s_add_u32 m0, s37, 24576
    s_mov_b32 s36, 262144
    buffer_load_dwordx4 v121, s[12:15], s36 offen lds
    s_add_u32 m0, s37, 28672
    s_mov_b32 s36, 327680
    buffer_load_dwordx4 v121, s[12:15], s36 offen lds
    s_add_u32 m0, s37, 32768
    s_mov_b32 s36, 393216
    buffer_load_dwordx4 v121, s[12:15], s36 offen lds
    s_add_u32 m0, s37, 36864
    s_mov_b32 s36, 458752
    buffer_load_dwordx4 v121, s[12:15], s36 offen lds
ld_1:
    s_mov_b32 s35, 0
    s_lshl_b32 s42, s40, 4
    s_add_u32 s42, s42, s41
    s_lshl_b32 s43, s42, 7
    s_lshl_b32 s42, s42, 18
    s_add_u32 s16, s50, s42
    s_addc_u32 s17, s51, 0
    s_mov_b32 s18, 262144
    s_mov_b32 s19, 0x00020000
    s_add_u32 s20, s52, s42
    s_addc_u32 s21, s53, 0
    s_mov_b32 s22, 262144
    s_mov_b32 s23, 0x00020000
    s_mov_b32 s24, s98
    s_mov_b32 s25, s99
    s_mov_b32 s26, 50331648
    s_mov_b32 s27, 0x00020000
    s_cmp_lg_u32 s28, 11
    s_cbranch_scc1 ow_2
    s_add_u32 s43, s43, 67108864
    v_lshlrev_b32 v122, 16, v7
    v_add_u32 v122, s43, v122
    v_mov_b32 v123, 0
    s_mov_b64 exec, 3
    global_store_dword v122, v123, s[98:99] sc1
    s_mov_b64 exec, -1
ow_2:
    s_lshl_b32 s43, s28, 11
    v_lshlrev_b32 v3, 4, v7
    v_add_u32 v6, s43, v3
    v_and_b32 v3, 16, v7
    v_xor_b32 v5, v6, v3
    s_mul_i32 s38, s28, 2112
    s_mul_i32 s39, s28, 2176
    v_and_b32 v3, 31, v7
    v_lshlrev_b32 v4, 7, v3
    s_lshl_b32 s42, s30, 12
    s_add_u32 s42, s42, 73728
    v_add_u32 v4, s42, v4
    v_bfe_u32 v3, v7, 1, 3
    v_lshrrev_b32 v0, 5, v7
    v_xor_b32 v3, v3, v0
    v_xor_b32 v1, 0, v3
    v_lshl_add_u32 v112, v1, 4, v4
    v_xor_b32 v1, 2, v3
    v_lshl_add_u32 v113, v1, 4, v4
    v_xor_b32 v1, 4, v3
    v_lshl_add_u32 v114, v1, 4, v4
    v_xor_b32 v1, 6, v3
    v_lshl_add_u32 v115, v1, 4, v4
    v_and_b32 v124, 16, v7
    v_lshlrev_b32 v124, 1, v124
    v_and_b32 v3, 1, v7
    v_lshl_add_u32 v124, v3, 4, v124
    v_and_b32 v3, 2, v7
    v_lshl_add_u32 v124, v3, 2, v124
    v_bfe_u32 v125, v7, 2, 2
    v_lshrrev_b32 v126, 5, v7
    v_lshl_add_u32 v3, v126, 3, v125
    v_lshl_add_u32 v3, v3, 9, v124
    s_lshl_b32 s42, s29, 8
    s_add_u32 s42, s42, 98304
    v_add_u32 v3, s42, v3
    v_xor_b32 v4, 0, v125
    v_lshl_add_u32 v116, v4, 6, v3
    v_xor_b32 v4, 1, v125
    v_lshl_add_u32 v117, v4, 6, v3
    v_xor_b32 v4, 2, v125
    v_lshl_add_u32 v118, v4, 6, v3
    v_xor_b32 v4, 3, v125
    v_lshl_add_u32 v119, v4, 6, v3
    s_mul_i32 s42, s29, 8704
    s_add_u32 s42, s42, 94208
    v_mul_u32_u24 v3, 1088, v125
    v_lshl_add_u32 v3, v126, 8, v3
    v_add3_u32 v1, v3, v124, s42
    v_bfe_u32 v3, v7, 4, 1
    v_and_b32 v4, 3, v7
    v_lshl_add_u32 v3, v3, 2, v4
    v_mul_u32_u24 v3, 1056, v3
    v_lshl_add_u32 v3, v125, 8, v3
    v_and_b32 v4, 1, v125
    v_xor_b32 v4, v4, v126
    v_lshl_add_u32 v3, v4, 4, v3
    s_mul_i32 s42, s29, 8448
    v_add_u32 v0, s42, v3
    s_mov_b32 s44, 0x3e0293ee
    s_mov_b32 s45, 0x3e0293ee
    s_mov_b32 s34, 0x41000000
    s_waitcnt vmcnt(4)
    s_barrier
    ds_read_b128 v[128:131], v112
    ds_read_b64_tr_b16 v[132:133], v116 offset:0
    ds_read_b64_tr_b16 v[134:135], v116 offset:2048
    ds_read_b64_tr_b16 v[136:137], v117 offset:0
    ds_read_b64_tr_b16 v[138:139], v117 offset:2048
    ds_read_b64_tr_b16 v[140:141], v118 offset:0
    ds_read_b64_tr_b16 v[142:143], v118 offset:2048
    ds_read_b64_tr_b16 v[144:145], v119 offset:0
    ds_read_b64_tr_b16 v[146:147], v119 offset:2048
    ds_read_b128 v[148:151], v113
    ds_read_b64_tr_b16 v[152:153], v116 offset:8192
    ds_read_b64_tr_b16 v[154:155], v116 offset:10240
    ds_read_b64_tr_b16 v[156:157], v117 offset:8192
    ds_read_b64_tr_b16 v[158:159], v117 offset:10240
    ds_read_b64_tr_b16 v[160:161], v118 offset:8192
    ds_read_b64_tr_b16 v[162:163], v118 offset:10240
    ds_read_b64_tr_b16 v[164:165], v119 offset:8192
    ds_read_b64_tr_b16 v[166:167], v119 offset:10240
    s_cmp_ge_u32 s28, 4
    s_cbranch_scc1 ld_3
    s_add_u32 m0, s37, 57344
    s_mov_b32 s36, 524288
    buffer_load_dwordx4 v121, s[12:15], s36 offen lds
    s_add_u32 m0, s37, 61440
    s_mov_b32 s36, 589824
    buffer_load_dwordx4 v121, s[12:15], s36 offen lds
    s_add_u32 m0, s37, 65536
    s_mov_b32 s36, 655360
    buffer_load_dwordx4 v121, s[12:15], s36 offen lds
    s_add_u32 m0, s37, 69632
    s_mov_b32 s36, 720896
    buffer_load_dwordx4 v121, s[12:15], s36 offen lds
    s_add_u32 m0, s37, 114688
    s_mov_b32 s36, 128
    buffer_load_dwordx4 v120, s[8:11], s36 offen lds
    s_add_u32 m0, s37, 118784
    s_mov_b32 s36, 32896
    buffer_load_dwordx4 v120, s[8:11], s36 offen lds
    s_add_u32 m0, s37, 122880
    s_mov_b32 s36, 65664
    buffer_load_dwordx4 v120, s[8:11], s36 offen lds
    s_add_u32 m0, s37, 126976
    s_mov_b32 s36, 98432
    buffer_load_dwordx4 v120, s[8:11], s36 offen lds
    s_add_u32 m0, s37, 131072
    s_mov_b32 s36, 131200
    buffer_load_dwordx4 v120, s[8:11], s36 offen lds
    s_add_u32 m0, s37, 135168
    s_mov_b32 s36, 163968
    buffer_load_dwordx4 v120, s[8:11], s36 offen lds
ld_3:
    s_waitcnt vmcnt(10) lgkmcnt(0)
    s_barrier
    v_mfma_f32_32x32x16_bf16 v[8:23], v[132:135], v[128:131], 0
    v_add_u32 v116, 0xfffee000, v116
    v_add_u32 v117, 0xfffee000, v117
    v_add_u32 v118, 0xfffee000, v118
    v_add_u32 v119, 0xfffee000, v119
    ds_read_b128 v[72:75], v114
    ds_read_b64_tr_b16 v[76:77], v116 offset:0
    ds_read_b64_tr_b16 v[78:79], v116 offset:2048
    v_mfma_f32_32x32x16_bf16 v[24:39], v[136:139], v[128:131], 0
    ds_read_b64_tr_b16 v[80:81], v117 offset:0
    ds_read_b64_tr_b16 v[82:83], v117 offset:2048
    ds_read_b64_tr_b16 v[84:85], v118 offset:0
    v_mfma_f32_32x32x16_bf16 v[40:55], v[140:143], v[128:131], 0
    ds_read_b64_tr_b16 v[86:87], v118 offset:2048
    ds_read_b64_tr_b16 v[88:89], v119 offset:0
    ds_read_b64_tr_b16 v[90:91], v119 offset:2048
    v_mfma_f32_32x32x16_bf16 v[56:71], v[144:147], v[128:131], 0
    ds_read_b128 v[92:95], v115
    ds_read_b64_tr_b16 v[96:97], v116 offset:8192
    ds_read_b64_tr_b16 v[98:99], v116 offset:10240
    v_mfma_f32_32x32x16_bf16 v[8:23], v[152:155], v[148:151], v[8:23]
    ds_read_b64_tr_b16 v[100:101], v117 offset:8192
    ds_read_b64_tr_b16 v[102:103], v117 offset:10240
    ds_read_b64_tr_b16 v[104:105], v118 offset:8192
    v_mfma_f32_32x32x16_bf16 v[24:39], v[156:159], v[148:151], v[24:39]
    ds_read_b64_tr_b16 v[106:107], v118 offset:10240
    ds_read_b64_tr_b16 v[108:109], v119 offset:8192
    ds_read_b64_tr_b16 v[110:111], v119 offset:10240
    v_mfma_f32_32x32x16_bf16 v[40:55], v[160:163], v[148:151], v[40:55]
    v_mfma_f32_32x32x16_bf16 v[56:71], v[164:167], v[148:151], v[56:71]
    s_cmp_ge_u32 s28, 4
    s_cbranch_scc1 ld_4
    s_add_u32 m0, s37, 139264
    s_mov_b32 s36, 786432
    buffer_load_dwordx4 v121, s[12:15], s36 offen lds
    s_add_u32 m0, s37, 143360
    s_mov_b32 s36, 851968
    buffer_load_dwordx4 v121, s[12:15], s36 offen lds
    s_add_u32 m0, s37, 147456
    s_mov_b32 s36, 917504
    buffer_load_dwordx4 v121, s[12:15], s36 offen lds
    s_add_u32 m0, s37, 151552
    s_mov_b32 s36, 983040
    buffer_load_dwordx4 v121, s[12:15], s36 offen lds
    s_add_u32 m0, s37, 0
    s_mov_b32 s36, 256
    buffer_load_dwordx4 v120, s[8:11], s36 offen lds
    s_add_u32 m0, s37, 4096
    s_mov_b32 s36, 33024
    buffer_load_dwordx4 v120, s[8:11], s36 offen lds
    s_add_u32 m0, s37, 8192
    s_mov_b32 s36, 65792
    buffer_load_dwordx4 v120, s[8:11], s36 offen lds
ld_4:
    s_waitcnt vmcnt(7) lgkmcnt(0)
    s_barrier
    v_mfma_f32_32x32x16_bf16 v[8:23], v[76:79], v[72:75], v[8:23]
    v_add_u32 v116, 0x8000, v116
    v_add_u32 v117, 0x8000, v117
    v_add_u32 v118, 0x8000, v118
    v_add_u32 v119, 0x8000, v119
    v_add_u32 v112, 0xa000, v112
    v_add_u32 v113, 0xa000, v113
    v_add_u32 v114, 0xa000, v114
    v_add_u32 v115, 0xa000, v115
    ds_read_b128 v[128:131], v112
    ds_read_b64_tr_b16 v[132:133], v116 offset:0
    ds_read_b64_tr_b16 v[134:135], v116 offset:2048
    v_mfma_f32_32x32x16_bf16 v[24:39], v[80:83], v[72:75], v[24:39]
    ds_read_b64_tr_b16 v[136:137], v117 offset:0
    ds_read_b64_tr_b16 v[138:139], v117 offset:2048
    ds_read_b64_tr_b16 v[140:141], v118 offset:0
    v_mfma_f32_32x32x16_bf16 v[40:55], v[84:87], v[72:75], v[40:55]
    ds_read_b64_tr_b16 v[142:143], v118 offset:2048
    ds_read_b64_tr_b16 v[144:145], v119 offset:0
    ds_read_b64_tr_b16 v[146:147], v119 offset:2048
    v_mfma_f32_32x32x16_bf16 v[56:71], v[88:91], v[72:75], v[56:71]
    ds_read_b128 v[148:151], v113
    ds_read_b64_tr_b16 v[152:153], v116 offset:8192
    ds_read_b64_tr_b16 v[154:155], v116 offset:10240
    v_mfma_f32_32x32x16_bf16 v[8:23], v[96:99], v[92:95], v[8:23]
    ds_read_b64_tr_b16 v[156:157], v117 offset:8192
    ds_read_b64_tr_b16 v[158:159], v117 offset:10240
    ds_read_b64_tr_b16 v[160:161], v118 offset:8192
    v_mfma_f32_32x32x16_bf16 v[24:39], v[100:103], v[92:95], v[24:39]
    ds_read_b64_tr_b16 v[162:163], v118 offset:10240
    ds_read_b64_tr_b16 v[164:165], v119 offset:8192
    ds_read_b64_tr_b16 v[166:167], v119 offset:10240
    v_mfma_f32_32x32x16_bf16 v[40:55], v[104:107], v[92:95], v[40:55]
    v_mfma_f32_32x32x16_bf16 v[56:71], v[108:111], v[92:95], v[56:71]
    s_cmp_ge_u32 s28, 4
    s_cbranch_scc1 ld_5
    s_add_u32 m0, s37, 12288
    s_mov_b32 s36, 98560
    buffer_load_dwordx4 v120, s[8:11], s36 offen lds
    s_add_u32 m0, s37, 16384
    s_mov_b32 s36, 131328
    buffer_load_dwordx4 v120, s[8:11], s36 offen lds
    s_add_u32 m0, s37, 20480
    s_mov_b32 s36, 164096
    buffer_load_dwordx4 v120, s[8:11], s36 offen lds
    s_add_u32 m0, s37, 40960
    s_mov_b32 s36, 1048576
    buffer_load_dwordx4 v121, s[12:15], s36 offen lds
    s_add_u32 m0, s37, 45056
    s_mov_b32 s36, 1114112
    buffer_load_dwordx4 v121, s[12:15], s36 offen lds
    s_add_u32 m0, s37, 49152
    s_mov_b32 s36, 1179648
    buffer_load_dwordx4 v121, s[12:15], s36 offen lds
    s_add_u32 m0, s37, 53248
    s_mov_b32 s36, 1245184
    buffer_load_dwordx4 v121, s[12:15], s36 offen lds
ld_5:
    s_waitcnt vmcnt(10) lgkmcnt(0)
    s_barrier
    v_mfma_f32_32x32x16_bf16 v[8:23], v[132:135], v[128:131], v[8:23]
    v_add_u32 v116, 0x14000, v116
    v_add_u32 v117, 0x14000, v117
    v_add_u32 v118, 0x14000, v118
    v_add_u32 v119, 0x14000, v119
    ds_read_b128 v[72:75], v114
    ds_read_b64_tr_b16 v[76:77], v116 offset:0
    ds_read_b64_tr_b16 v[78:79], v116 offset:2048
    v_mfma_f32_32x32x16_bf16 v[24:39], v[136:139], v[128:131], v[24:39]
    ds_read_b64_tr_b16 v[80:81], v117 offset:0
    ds_read_b64_tr_b16 v[82:83], v117 offset:2048
    ds_read_b64_tr_b16 v[84:85], v118 offset:0
    v_mfma_f32_32x32x16_bf16 v[40:55], v[140:143], v[128:131], v[40:55]
    ds_read_b64_tr_b16 v[86:87], v118 offset:2048
    ds_read_b64_tr_b16 v[88:89], v119 offset:0
    ds_read_b64_tr_b16 v[90:91], v119 offset:2048
    v_mfma_f32_32x32x16_bf16 v[56:71], v[144:147], v[128:131], v[56:71]
    ds_read_b128 v[92:95], v115
    ds_read_b64_tr_b16 v[96:97], v116 offset:8192
    ds_read_b64_tr_b16 v[98:99], v116 offset:10240
    v_mfma_f32_32x32x16_bf16 v[8:23], v[152:155], v[148:151], v[8:23]
    ds_read_b64_tr_b16 v[100:101], v117 offset:8192
    ds_read_b64_tr_b16 v[102:103], v117 offset:10240
    ds_read_b64_tr_b16 v[104:105], v118 offset:8192
    v_mfma_f32_32x32x16_bf16 v[24:39], v[156:159], v[148:151], v[24:39]
    ds_read_b64_tr_b16 v[106:107], v118 offset:10240
    ds_read_b64_tr_b16 v[108:109], v119 offset:8192
    ds_read_b64_tr_b16 v[110:111], v119 offset:10240
    v_mfma_f32_32x32x16_bf16 v[40:55], v[160:163], v[148:151], v[40:55]
    v_mfma_f32_32x32x16_bf16 v[56:71], v[164:167], v[148:151], v[56:71]
    s_cmp_ge_u32 s28, 4
    s_cbranch_scc1 ld_6
    s_add_u32 m0, s37, 98304
    s_mov_b32 s36, 1310720
    buffer_load_dwordx4 v121, s[12:15], s36 offen lds
    s_add_u32 m0, s37, 102400
    s_mov_b32 s36, 1376256
    buffer_load_dwordx4 v121, s[12:15], s36 offen lds
    s_add_u32 m0, s37, 106496
    s_mov_b32 s36, 1441792
    buffer_load_dwordx4 v121, s[12:15], s36 offen lds
    s_add_u32 m0, s37, 110592
    s_mov_b32 s36, 1507328
    buffer_load_dwordx4 v121, s[12:15], s36 offen lds
    s_add_u32 m0, s37, 73728
    s_mov_b32 s36, 384
    buffer_load_dwordx4 v120, s[8:11], s36 offen lds
    s_add_u32 m0, s37, 77824
    s_mov_b32 s36, 33152
    buffer_load_dwordx4 v120, s[8:11], s36 offen lds
    s_add_u32 m0, s37, 81920
    s_mov_b32 s36, 65920
    buffer_load_dwordx4 v120, s[8:11], s36 offen lds
ld_6:
    s_waitcnt vmcnt(7) lgkmcnt(0)
    s_barrier
    v_mfma_f32_32x32x16_bf16 v[8:23], v[76:79], v[72:75], v[8:23]
    v_add_u32 v116, 0xfffe8000, v116
    v_add_u32 v117, 0xfffe8000, v117
    v_add_u32 v118, 0xfffe8000, v118
    v_add_u32 v119, 0xfffe8000, v119
    v_add_u32 v112, 0xfffe4000, v112
    v_add_u32 v113, 0xfffe4000, v113
    v_add_u32 v114, 0xfffe4000, v114
    v_add_u32 v115, 0xfffe4000, v115
    ds_read_b128 v[128:131], v112
    ds_read_b64_tr_b16 v[132:133], v116 offset:0
    ds_read_b64_tr_b16 v[134:135], v116 offset:2048
    v_mfma_f32_32x32x16_bf16 v[24:39], v[80:83], v[72:75], v[24:39]
    ds_read_b64_tr_b16 v[136:137], v117 offset:0
    ds_read_b64_tr_b16 v[138:139], v117 offset:2048
    ds_read_b64_tr_b16 v[140:141], v118 offset:0
    v_mfma_f32_32x32x16_bf16 v[40:55], v[84:87], v[72:75], v[40:55]
    ds_read_b64_tr_b16 v[142:143], v118 offset:2048
    ds_read_b64_tr_b16 v[144:145], v119 offset:0
    ds_read_b64_tr_b16 v[146:147], v119 offset:2048
    v_mfma_f32_32x32x16_bf16 v[56:71], v[88:91], v[72:75], v[56:71]
    ds_read_b128 v[148:151], v113
    ds_read_b64_tr_b16 v[152:153], v116 offset:8192
    ds_read_b64_tr_b16 v[154:155], v116 offset:10240
    v_mfma_f32_32x32x16_bf16 v[8:23], v[96:99], v[92:95], v[8:23]
    ds_read_b64_tr_b16 v[156:157], v117 offset:8192
    ds_read_b64_tr_b16 v[158:159], v117 offset:10240
    ds_read_b64_tr_b16 v[160:161], v118 offset:8192
    v_mfma_f32_32x32x16_bf16 v[24:39], v[100:103], v[92:95], v[24:39]
    ds_read_b64_tr_b16 v[162:163], v118 offset:10240
    ds_read_b64_tr_b16 v[164:165], v119 offset:8192
    ds_read_b64_tr_b16 v[166:167], v119 offset:10240
    v_mfma_f32_32x32x16_bf16 v[40:55], v[104:107], v[92:95], v[40:55]
    v_mfma_f32_32x32x16_bf16 v[56:71], v[108:111], v[92:95], v[56:71]
    s_cmp_ge_u32 s28, 4
    s_cbranch_scc1 ld_7
    s_add_u32 m0, s37, 86016
    s_mov_b32 s36, 98688
    buffer_load_dwordx4 v120, s[8:11], s36 offen lds
    s_add_u32 m0, s37, 90112
    s_mov_b32 s36, 131456
    buffer_load_dwordx4 v120, s[8:11], s36 offen lds
    s_add_u32 m0, s37, 94208
    s_mov_b32 s36, 164224
    buffer_load_dwordx4 v120, s[8:11], s36 offen lds
    s_add_u32 m0, s37, 24576
    s_mov_b32 s36, 1572864
    buffer_load_dwordx4 v121, s[12:15], s36 offen lds
    s_add_u32 m0, s37, 28672
    s_mov_b32 s36, 1638400
    buffer_load_dwordx4 v121, s[12:15], s36 offen lds
    s_add_u32 m0, s37, 32768
    s_mov_b32 s36, 1703936
    buffer_load_dwordx4 v121, s[12:15], s36 offen lds
    s_add_u32 m0, s37, 36864
    s_mov_b32 s36, 1769472
    buffer_load_dwordx4 v121, s[12:15], s36 offen lds
    s_add_u32 m0, s37, 57344
    s_mov_b32 s36, 1835008
    buffer_load_dwordx4 v121, s[12:15], s36 offen lds
    s_add_u32 m0, s37, 61440
    s_mov_b32 s36, 1900544
    buffer_load_dwordx4 v121, s[12:15], s36 offen lds
    s_add_u32 m0, s37, 65536
    s_mov_b32 s36, 1966080
    buffer_load_dwordx4 v121, s[12:15], s36 offen lds
    s_add_u32 m0, s37, 69632
    s_mov_b32 s36, 2031616
    buffer_load_dwordx4 v121, s[12:15], s36 offen lds
ld_7:
    s_waitcnt vmcnt(14) lgkmcnt(0)
    s_barrier
    v_mfma_f32_32x32x16_bf16 v[8:23], v[132:135], v[128:131], v[8:23]
    v_add_u32 v116, 0xe000, v116
    v_add_u32 v117, 0xe000, v117
    v_add_u32 v118, 0xe000, v118
    v_add_u32 v119, 0xe000, v119
    ds_read_b128 v[72:75], v114
    ds_read_b64_tr_b16 v[76:77], v116 offset:0
    ds_read_b64_tr_b16 v[78:79], v116 offset:2048
    v_mfma_f32_32x32x16_bf16 v[24:39], v[136:139], v[128:131], v[24:39]
    ds_read_b64_tr_b16 v[80:81], v117 offset:0
    ds_read_b64_tr_b16 v[82:83], v117 offset:2048
    ds_read_b64_tr_b16 v[84:85], v118 offset:0
    v_mfma_f32_32x32x16_bf16 v[40:55], v[140:143], v[128:131], v[40:55]
    ds_read_b64_tr_b16 v[86:87], v118 offset:2048
    ds_read_b64_tr_b16 v[88:89], v119 offset:0
    ds_read_b64_tr_b16 v[90:91], v119 offset:2048
    v_mfma_f32_32x32x16_bf16 v[56:71], v[144:147], v[128:131], v[56:71]
    ds_read_b128 v[92:95], v115
    ds_read_b64_tr_b16 v[96:97], v116 offset:8192
    ds_read_b64_tr_b16 v[98:99], v116 offset:10240
    v_mfma_f32_32x32x16_bf16 v[8:23], v[152:155], v[148:151], v[8:23]
    ds_read_b64_tr_b16 v[100:101], v117 offset:8192
    ds_read_b64_tr_b16 v[102:103], v117 offset:10240
    ds_read_b64_tr_b16 v[104:105], v118 offset:8192
    v_mfma_f32_32x32x16_bf16 v[24:39], v[156:159], v[148:151], v[24:39]
    ds_read_b64_tr_b16 v[106:107], v118 offset:10240
    ds_read_b64_tr_b16 v[108:109], v119 offset:8192
    ds_read_b64_tr_b16 v[110:111], v119 offset:10240
    v_mfma_f32_32x32x16_bf16 v[40:55], v[160:163], v[148:151], v[40:55]
    v_mfma_f32_32x32x16_bf16 v[56:71], v[164:167], v[148:151], v[56:71]
    s_cmp_ge_u32 s28, 4
    s_cbranch_scc1 ld_8
    s_add_u32 m0, s37, 114688
    s_mov_b32 s36, 512
    buffer_load_dwordx4 v120, s[8:11], s36 offen lds
    s_add_u32 m0, s37, 118784
    s_mov_b32 s36, 33280
    buffer_load_dwordx4 v120, s[8:11], s36 offen lds
    s_add_u32 m0, s37, 122880
    s_mov_b32 s36, 66048
    buffer_load_dwordx4 v120, s[8:11], s36 offen lds
    s_add_u32 m0, s37, 139264
    s_mov_b32 s36, 2097152
    buffer_load_dwordx4 v121, s[12:15], s36 offen lds
    s_add_u32 m0, s37, 143360
    s_mov_b32 s36, 2162688
    buffer_load_dwordx4 v121, s[12:15], s36 offen lds
    s_add_u32 m0, s37, 147456
    s_mov_b32 s36, 2228224
    buffer_load_dwordx4 v121, s[12:15], s36 offen lds
    s_add_u32 m0, s37, 151552
    s_mov_b32 s36, 2293760
    buffer_load_dwordx4 v121, s[12:15], s36 offen lds
ld_8:
    s_waitcnt vmcnt(11) lgkmcnt(0)
    s_barrier
    v_mfma_f32_32x32x16_bf16 v[8:23], v[76:79], v[72:75], v[8:23]
    v_add_u32 v116, 0xfffee000, v116
    v_add_u32 v117, 0xfffee000, v117
    v_add_u32 v118, 0xfffee000, v118
    v_add_u32 v119, 0xfffee000, v119
    v_add_u32 v112, 0x12000, v112
    v_add_u32 v113, 0x12000, v113
    v_add_u32 v114, 0x12000, v114
    v_add_u32 v115, 0x12000, v115
    ds_read_b128 v[128:131], v112
    ds_read_b64_tr_b16 v[132:133], v116 offset:0
    ds_read_b64_tr_b16 v[134:135], v116 offset:2048
    v_mfma_f32_32x32x16_bf16 v[24:39], v[80:83], v[72:75], v[24:39]
    ds_read_b64_tr_b16 v[136:137], v117 offset:0
    ds_read_b64_tr_b16 v[138:139], v117 offset:2048
    ds_read_b64_tr_b16 v[140:141], v118 offset:0
    v_mfma_f32_32x32x16_bf16 v[40:55], v[84:87], v[72:75], v[40:55]
    ds_read_b64_tr_b16 v[142:143], v118 offset:2048
    ds_read_b64_tr_b16 v[144:145], v119 offset:0
    ds_read_b64_tr_b16 v[146:147], v119 offset:2048
    v_mfma_f32_32x32x16_bf16 v[56:71], v[88:91], v[72:75], v[56:71]
    ds_read_b128 v[148:151], v113
    ds_read_b64_tr_b16 v[152:153], v116 offset:8192
    ds_read_b64_tr_b16 v[154:155], v116 offset:10240
    v_mfma_f32_32x32x16_bf16 v[8:23], v[96:99], v[92:95], v[8:23]
    ds_read_b64_tr_b16 v[156:157], v117 offset:8192
    ds_read_b64_tr_b16 v[158:159], v117 offset:10240
    ds_read_b64_tr_b16 v[160:161], v118 offset:8192
    v_mfma_f32_32x32x16_bf16 v[24:39], v[100:103], v[92:95], v[24:39]
    ds_read_b64_tr_b16 v[162:163], v118 offset:10240
    ds_read_b64_tr_b16 v[164:165], v119 offset:8192
    ds_read_b64_tr_b16 v[166:167], v119 offset:10240
    v_mfma_f32_32x32x16_bf16 v[40:55], v[104:107], v[92:95], v[40:55]
    v_mfma_f32_32x32x16_bf16 v[56:71], v[108:111], v[92:95], v[56:71]
    s_cmp_ge_u32 s28, 4
    s_cbranch_scc1 ld_9
    s_add_u32 m0, s37, 126976
    s_mov_b32 s36, 98816
    buffer_load_dwordx4 v120, s[8:11], s36 offen lds
    s_add_u32 m0, s37, 131072
    s_mov_b32 s36, 131584
    buffer_load_dwordx4 v120, s[8:11], s36 offen lds
    s_add_u32 m0, s37, 135168
    s_mov_b32 s36, 164352
    buffer_load_dwordx4 v120, s[8:11], s36 offen lds
    s_add_u32 m0, s37, 40960
    s_mov_b32 s36, 2359296
    buffer_load_dwordx4 v121, s[12:15], s36 offen lds
    s_add_u32 m0, s37, 45056
    s_mov_b32 s36, 2424832
    buffer_load_dwordx4 v121, s[12:15], s36 offen lds
    s_add_u32 m0, s37, 49152
    s_mov_b32 s36, 2490368
    buffer_load_dwordx4 v121, s[12:15], s36 offen lds
    s_add_u32 m0, s37, 53248
    s_mov_b32 s36, 2555904
    buffer_load_dwordx4 v121, s[12:15], s36 offen lds
    s_add_u32 m0, s37, 98304
    s_mov_b32 s36, 2621440
    buffer_load_dwordx4 v121, s[12:15], s36 offen lds
    s_add_u32 m0, s37, 102400
    s_mov_b32 s36, 2686976
    buffer_load_dwordx4 v121, s[12:15], s36 offen lds
    s_add_u32 m0, s37, 106496
    s_mov_b32 s36, 2752512
    buffer_load_dwordx4 v121, s[12:15], s36 offen lds
    s_add_u32 m0, s37, 110592
    s_mov_b32 s36, 2818048
    buffer_load_dwordx4 v121, s[12:15], s36 offen lds
ld_9:
    s_cmp_lg_u32 s28, 11
    s_cbranch_scc1 ow_10
    s_waitcnt vmcnt(0)
    s_lshl_b32 s42, s40, 4
    v_mov_b32 v122, s42
    v_mov_b32 v123, 1
    s_mov_b64 exec, 1
    global_atomic_add v122, v123, s[96:97] sc1
    s_mov_b64 exec, -1
ow_10:
    s_waitcnt vmcnt(18) lgkmcnt(0)
    s_barrier
    v_mfma_f32_32x32x16_bf16 v[8:23], v[132:135], v[128:131], v[8:23]
    v_add_u32 v116, 0x8000, v116
    v_add_u32 v117, 0x8000, v117
    v_add_u32 v118, 0x8000, v118
    v_add_u32 v119, 0x8000, v119
    ds_read_b128 v[72:75], v114
    ds_read_b64_tr_b16 v[76:77], v116 offset:0
    ds_read_b64_tr_b16 v[78:79], v116 offset:2048
    v_mfma_f32_32x32x16_bf16 v[24:39], v[136:139], v[128:131], v[24:39]
    ds_read_b64_tr_b16 v[80:81], v117 offset:0
    ds_read_b64_tr_b16 v[82:83], v117 offset:2048
    ds_read_b64_tr_b16 v[84:85], v118 offset:0
    v_mfma_f32_32x32x16_bf16 v[40:55], v[140:143], v[128:131], v[40:55]
    ds_read_b64_tr_b16 v[86:87], v118 offset:2048
    ds_read_b64_tr_b16 v[88:89], v119 offset:0
    ds_read_b64_tr_b16 v[90:91], v119 offset:2048
    v_mfma_f32_32x32x16_bf16 v[56:71], v[144:147], v[128:131], v[56:71]
    ds_read_b128 v[92:95], v115
    ds_read_b64_tr_b16 v[96:97], v116 offset:8192
    ds_read_b64_tr_b16 v[98:99], v116 offset:10240
    v_mfma_f32_32x32x16_bf16 v[8:23], v[152:155], v[148:151], v[8:23]
    ds_read_b64_tr_b16 v[100:101], v117 offset:8192
    ds_read_b64_tr_b16 v[102:103], v117 offset:10240
    ds_read_b64_tr_b16 v[104:105], v118 offset:8192
    v_mfma_f32_32x32x16_bf16 v[24:39], v[156:159], v[148:151], v[24:39]
    ds_read_b64_tr_b16 v[106:107], v118 offset:10240
    ds_read_b64_tr_b16 v[108:109], v119 offset:8192
    ds_read_b64_tr_b16 v[110:111], v119 offset:10240
    v_mfma_f32_32x32x16_bf16 v[40:55], v[160:163], v[148:151], v[40:55]
    v_mfma_f32_32x32x16_bf16 v[56:71], v[164:167], v[148:151], v[56:71]
    s_cmp_ge_u32 s28, 4
    s_cbranch_scc1 ld_11
    s_add_u32 m0, s38, 0
    s_mov_b32 s36, 0
    buffer_load_dwordx4 v5, s[16:19], s36 offen nt lds
    s_add_u32 m0, s38, 32
    s_nop 0
    buffer_load_dwordx4 v5, s[16:19], s36 offen offset:1024 nt lds
    s_add_u32 m0, s38, 8448
    s_mov_b32 s36, 131072
    buffer_load_dwordx4 v5, s[16:19], s36 offen nt lds
    s_add_u32 m0, s38, 8480
    s_nop 0
    buffer_load_dwordx4 v5, s[16:19], s36 offen offset:1024 nt lds
ld_11:
    s_waitcnt vmcnt(12) lgkmcnt(0)
    s_barrier
    v_mfma_f32_32x32x16_bf16 v[8:23], v[76:79], v[72:75], v[8:23]
    v_add_u32 v116, 0x14000, v116
    v_add_u32 v117, 0x14000, v117
    v_add_u32 v118, 0x14000, v118
    v_add_u32 v119, 0x14000, v119
    v_add_u32 v112, 0xa000, v112
    v_add_u32 v113, 0xa000, v113
    v_add_u32 v114, 0xa000, v114
    v_add_u32 v115, 0xa000, v115
    ds_read_b128 v[128:131], v112
    ds_read_b64_tr_b16 v[132:133], v116 offset:0
    ds_read_b64_tr_b16 v[134:135], v116 offset:2048
    v_mfma_f32_32x32x16_bf16 v[24:39], v[80:83], v[72:75], v[24:39]
    ds_read_b64_tr_b16 v[136:137], v117 offset:0
    ds_read_b64_tr_b16 v[138:139], v117 offset:2048
    ds_read_b64_tr_b16 v[140:141], v118 offset:0
    v_mfma_f32_32x32x16_bf16 v[40:55], v[84:87], v[72:75], v[40:55]
    ds_read_b64_tr_b16 v[142:143], v118 offset:2048
    ds_read_b64_tr_b16 v[144:145], v119 offset:0
    ds_read_b64_tr_b16 v[146:147], v119 offset:2048
    v_mfma_f32_32x32x16_bf16 v[56:71], v[88:91], v[72:75], v[56:71]
    ds_read_b128 v[148:151], v113
    ds_read_b64_tr_b16 v[152:153], v116 offset:8192
    ds_read_b64_tr_b16 v[154:155], v116 offset:10240
    v_mfma_f32_32x32x16_bf16 v[8:23], v[96:99], v[92:95], v[8:23]
    ds_read_b64_tr_b16 v[156:157], v117 offset:8192
    ds_read_b64_tr_b16 v[158:159], v117 offset:10240
    ds_read_b64_tr_b16 v[160:161], v118 offset:8192
    v_mfma_f32_32x32x16_bf16 v[24:39], v[100:103], v[92:95], v[24:39]
    ds_read_b64_tr_b16 v[162:163], v118 offset:10240
    ds_read_b64_tr_b16 v[164:165], v119 offset:8192
    ds_read_b64_tr_b16 v[166:167], v119 offset:10240
    v_mfma_f32_32x32x16_bf16 v[40:55], v[104:107], v[92:95], v[40:55]
    v_mfma_f32_32x32x16_bf16 v[56:71], v[108:111], v[92:95], v[56:71]
    s_cmp_ge_u32 s28, 4
    s_cbranch_scc1 ld_12
    s_add_u32 m0, s37, 73728
    s_mov_b32 s36, 640
    buffer_load_dwordx4 v120, s[8:11], s36 offen lds
    s_add_u32 m0, s37, 77824
    s_mov_b32 s36, 33408
    buffer_load_dwordx4 v120, s[8:11], s36 offen lds
    s_add_u32 m0, s37, 81920
    s_mov_b32 s36, 66176
    buffer_load_dwordx4 v120, s[8:11], s36 offen lds
    s_add_u32 m0, s37, 86016
    s_mov_b32 s36, 98944
    buffer_load_dwordx4 v120, s[8:11], s36 offen lds
    s_add_u32 m0, s37, 90112
    s_mov_b32 s36, 131712
    buffer_load_dwordx4 v120, s[8:11], s36 offen lds
    s_add_u32 m0, s37, 94208
    s_mov_b32 s36, 164480
    buffer_load_dwordx4 v120, s[8:11], s36 offen lds
    s_add_u32 m0, s37, 57344
    s_mov_b32 s36, 2883584
    buffer_load_dwordx4 v121, s[12:15], s36 offen lds
    s_add_u32 m0, s37, 61440
    s_mov_b32 s36, 2949120
    buffer_load_dwordx4 v121, s[12:15], s36 offen lds
    s_add_u32 m0, s37, 65536
    s_mov_b32 s36, 3014656
    buffer_load_dwordx4 v121, s[12:15], s36 offen lds
    s_add_u32 m0, s37, 69632
    s_mov_b32 s36, 3080192
    buffer_load_dwordx4 v121, s[12:15], s36 offen lds
ld_12:
    s_waitcnt vmcnt(18) lgkmcnt(0)
    s_barrier
    v_mfma_f32_32x32x16_bf16 v[8:23], v[132:135], v[128:131], v[8:23]
    v_add_u32 v116, 0xfffe8000, v116
    v_add_u32 v117, 0xfffe8000, v117
    v_add_u32 v118, 0xfffe8000, v118
    v_add_u32 v119, 0xfffe8000, v119
    ds_read_b128 v[72:75], v114
    ds_read_b64_tr_b16 v[76:77], v116 offset:0
    ds_read_b64_tr_b16 v[78:79], v116 offset:2048
    v_mfma_f32_32x32x16_bf16 v[24:39], v[136:139], v[128:131], v[24:39]
    ds_read_b64_tr_b16 v[80:81], v117 offset:0
    ds_read_b64_tr_b16 v[82:83], v117 offset:2048
    ds_read_b64_tr_b16 v[84:85], v118 offset:0
    v_mfma_f32_32x32x16_bf16 v[40:55], v[140:143], v[128:131], v[40:55]
    ds_read_b64_tr_b16 v[86:87], v118 offset:2048
    ds_read_b64_tr_b16 v[88:89], v119 offset:0
    ds_read_b64_tr_b16 v[90:91], v119 offset:2048
    v_mfma_f32_32x32x16_bf16 v[56:71], v[144:147], v[128:131], v[56:71]
    ds_read_b128 v[92:95], v115
    ds_read_b64_tr_b16 v[96:97], v116 offset:8192
    ds_read_b64_tr_b16 v[98:99], v116 offset:10240
    v_mfma_f32_32x32x16_bf16 v[8:23], v[152:155], v[148:151], v[8:23]
    ds_read_b64_tr_b16 v[100:101], v117 offset:8192
    ds_read_b64_tr_b16 v[102:103], v117 offset:10240
    ds_read_b64_tr_b16 v[104:105], v118 offset:8192
    v_mfma_f32_32x32x16_bf16 v[24:39], v[156:159], v[148:151], v[24:39]
    ds_read_b64_tr_b16 v[106:107], v118 offset:10240
    ds_read_b64_tr_b16 v[108:109], v119 offset:8192
    ds_read_b64_tr_b16 v[110:111], v119 offset:10240
    v_mfma_f32_32x32x16_bf16 v[40:55], v[160:163], v[148:151], v[40:55]
    v_mfma_f32_32x32x16_bf16 v[56:71], v[164:167], v[148:151], v[56:71]
    s_cmp_ge_u32 s28, 4
    s_cbranch_scc1 ld_13
    s_add_u32 m0, s37, 139264
    s_mov_b32 s36, 3145728
    buffer_load_dwordx4 v121, s[12:15], s36 offen lds
    s_add_u32 m0, s37, 143360
    s_mov_b32 s36, 3211264
    buffer_load_dwordx4 v121, s[12:15], s36 offen lds
    s_add_u32 m0, s37, 147456
    s_mov_b32 s36, 3276800
    buffer_load_dwordx4 v121, s[12:15], s36 offen lds
    s_add_u32 m0, s37, 151552
    s_mov_b32 s36, 3342336
    buffer_load_dwordx4 v121, s[12:15], s36 offen lds
    s_add_u32 m0, s38, 16896
    s_mov_b32 s36, 8192
    buffer_load_dwordx4 v5, s[16:19], s36 offen nt lds
    s_add_u32 m0, s38, 16928
    s_nop 0
    buffer_load_dwordx4 v5, s[16:19], s36 offen offset:1024 nt lds
    s_add_u32 m0, s38, 25344
    s_mov_b32 s36, 139264
    buffer_load_dwordx4 v5, s[16:19], s36 offen nt lds
    s_add_u32 m0, s38, 25376
    s_nop 0
    buffer_load_dwordx4 v5, s[16:19], s36 offen offset:1024 nt lds
ld_13:
    s_waitcnt vmcnt(12) lgkmcnt(0)
    s_barrier
    v_mfma_f32_32x32x16_bf16 v[8:23], v[76:79], v[72:75], v[8:23]
    v_add_u32 v116, 0xe000, v116
    v_add_u32 v117, 0xe000, v117
    v_add_u32 v118, 0xe000, v118
    v_add_u32 v119, 0xe000, v119
    v_add_u32 v112, 0xffff6000, v112
    v_add_u32 v113, 0xffff6000, v113
    v_add_u32 v114, 0xffff6000, v114
    v_add_u32 v115, 0xffff6000, v115
    ds_read_b128 v[128:131], v112
    ds_read_b64_tr_b16 v[132:133], v116 offset:0
    ds_read_b64_tr_b16 v[134:135], v116 offset:2048
    v_mfma_f32_32x32x16_bf16 v[24:39], v[80:83], v[72:75], v[24:39]
    ds_read_b64_tr_b16 v[136:137], v117 offset:0
    ds_read_b64_tr_b16 v[138:139], v117 offset:2048
    ds_read_b64_tr_b16 v[140:141], v118 offset:0
    v_mfma_f32_32x32x16_bf16 v[40:55], v[84:87], v[72:75], v[40:55]
    ds_read_b64_tr_b16 v[142:143], v118 offset:2048
    ds_read_b64_tr_b16 v[144:145], v119 offset:0
    ds_read_b64_tr_b16 v[146:147], v119 offset:2048
    v_mfma_f32_32x32x16_bf16 v[56:71], v[88:91], v[72:75], v[56:71]
    ds_read_b128 v[148:151], v113
    ds_read_b64_tr_b16 v[152:153], v116 offset:8192
    ds_read_b64_tr_b16 v[154:155], v116 offset:10240
    v_mfma_f32_32x32x16_bf16 v[8:23], v[96:99], v[92:95], v[8:23]
    ds_read_b64_tr_b16 v[156:157], v117 offset:8192
    ds_read_b64_tr_b16 v[158:159], v117 offset:10240
    ds_read_b64_tr_b16 v[160:161], v118 offset:8192
    v_mfma_f32_32x32x16_bf16 v[24:39], v[100:103], v[92:95], v[24:39]
    ds_read_b64_tr_b16 v[162:163], v118 offset:10240
    ds_read_b64_tr_b16 v[164:165], v119 offset:8192
    ds_read_b64_tr_b16 v[166:167], v119 offset:10240
    v_mfma_f32_32x32x16_bf16 v[40:55], v[104:107], v[92:95], v[40:55]
    v_mfma_f32_32x32x16_bf16 v[56:71], v[108:111], v[92:95], v[56:71]
    s_cmp_ge_u32 s28, 4
    s_cbranch_scc1 ld_14
    s_add_u32 m0, s37, 114688
    s_mov_b32 s36, 768
    buffer_load_dwordx4 v120, s[8:11], s36 offen lds
    s_add_u32 m0, s37, 118784
    s_mov_b32 s36, 33536
    buffer_load_dwordx4 v120, s[8:11], s36 offen lds
    s_add_u32 m0, s37, 122880
    s_mov_b32 s36, 66304
    buffer_load_dwordx4 v120, s[8:11], s36 offen lds
    s_add_u32 m0, s37, 126976
    s_mov_b32 s36, 99072
    buffer_load_dwordx4 v120, s[8:11], s36 offen lds
    s_add_u32 m0, s37, 131072
    s_mov_b32 s36, 131840
    buffer_load_dwordx4 v120, s[8:11], s36 offen lds
    s_add_u32 m0, s37, 135168
    s_mov_b32 s36, 164608
    buffer_load_dwordx4 v120, s[8:11], s36 offen lds
    s_add_u32 m0, s37, 40960
    s_mov_b32 s36, 3407872
    buffer_load_dwordx4 v121, s[12:15], s36 offen lds
    s_add_u32 m0, s37, 45056
    s_mov_b32 s36, 3473408
    buffer_load_dwordx4 v121, s[12:15], s36 offen lds
    s_add_u32 m0, s37, 49152
    s_mov_b32 s36, 3538944
    buffer_load_dwordx4 v121, s[12:15], s36 offen lds
    s_add_u32 m0, s37, 53248
    s_mov_b32 s36, 3604480
    buffer_load_dwordx4 v121, s[12:15], s36 offen lds
ld_14:
    s_waitcnt vmcnt(18) lgkmcnt(0)
    s_barrier
    v_mfma_f32_32x32x16_bf16 v[8:23], v[132:135], v[128:131], v[8:23]
    v_add_u32 v116, 0xffff6000, v116
    v_add_u32 v117, 0xffff6000, v117
    v_add_u32 v118, 0xffff6000, v118
    v_add_u32 v119, 0xffff6000, v119
    ds_read_b128 v[72:75], v114
    ds_read_b64_tr_b16 v[76:77], v116 offset:0
    ds_read_b64_tr_b16 v[78:79], v116 offset:2048
    v_mfma_f32_32x32x16_bf16 v[24:39], v[136:139], v[128:131], v[24:39]
    ds_read_b64_tr_b16 v[80:81], v117 offset:0
    ds_read_b64_tr_b16 v[82:83], v117 offset:2048
    ds_read_b64_tr_b16 v[84:85], v118 offset:0
    v_mfma_f32_32x32x16_bf16 v[40:55], v[140:143], v[128:131], v[40:55]
    ds_read_b64_tr_b16 v[86:87], v118 offset:2048
    ds_read_b64_tr_b16 v[88:89], v119 offset:0
    ds_read_b64_tr_b16 v[90:91], v119 offset:2048
    v_mfma_f32_32x32x16_bf16 v[56:71], v[144:147], v[128:131], v[56:71]
    ds_read_b128 v[92:95], v115
    ds_read_b64_tr_b16 v[96:97], v116 offset:8192
    ds_read_b64_tr_b16 v[98:99], v116 offset:10240
    v_mfma_f32_32x32x16_bf16 v[8:23], v[152:155], v[148:151], v[8:23]
    ds_read_b64_tr_b16 v[100:101], v117 offset:8192
    ds_read_b64_tr_b16 v[102:103], v117 offset:10240
    ds_read_b64_tr_b16 v[104:105], v118 offset:8192
    v_mfma_f32_32x32x16_bf16 v[24:39], v[156:159], v[148:151], v[24:39]
    ds_read_b64_tr_b16 v[106:107], v118 offset:10240
    ds_read_b64_tr_b16 v[108:109], v119 offset:8192
    ds_read_b64_tr_b16 v[110:111], v119 offset:10240
    v_mfma_f32_32x32x16_bf16 v[40:55], v[160:163], v[148:151], v[40:55]
    v_mfma_f32_32x32x16_bf16 v[56:71], v[164:167], v[148:151], v[56:71]
    s_cmp_ge_u32 s28, 4
    s_cbranch_scc1 ld_15
    s_add_u32 m0, s37, 98304
    s_mov_b32 s36, 3670016
    buffer_load_dwordx4 v121, s[12:15], s36 offen lds
    s_add_u32 m0, s37, 102400
    s_mov_b32 s36, 3735552
    buffer_load_dwordx4 v121, s[12:15], s36 offen lds
    s_add_u32 m0, s37, 106496
    s_mov_b32 s36, 3801088
    buffer_load_dwordx4 v121, s[12:15], s36 offen lds
    s_add_u32 m0, s37, 110592
    s_mov_b32 s36, 3866624
    buffer_load_dwordx4 v121, s[12:15], s36 offen lds
ld_15:
    s_waitcnt vmcnt(8) lgkmcnt(0)
    s_barrier
    v_mfma_f32_32x32x16_bf16 v[8:23], v[76:79], v[72:75], v[8:23]
    v_add_u32 v116, 0x14000, v116
    v_add_u32 v117, 0x14000, v117
    v_add_u32 v118, 0x14000, v118
    v_add_u32 v119, 0x14000, v119
    v_add_u32 v112, 0xa000, v112
    v_add_u32 v113, 0xa000, v113
    v_add_u32 v114, 0xa000, v114
    v_add_u32 v115, 0xa000, v115
    ds_read_b128 v[128:131], v112
    ds_read_b64_tr_b16 v[132:133], v116 offset:0
    ds_read_b64_tr_b16 v[134:135], v116 offset:2048
    v_mfma_f32_32x32x16_bf16 v[24:39], v[80:83], v[72:75], v[24:39]
    ds_read_b64_tr_b16 v[136:137], v117 offset:0
    ds_read_b64_tr_b16 v[138:139], v117 offset:2048
    ds_read_b64_tr_b16 v[140:141], v118 offset:0
    v_mfma_f32_32x32x16_bf16 v[40:55], v[84:87], v[72:75], v[40:55]
    ds_read_b64_tr_b16 v[142:143], v118 offset:2048
    ds_read_b64_tr_b16 v[144:145], v119 offset:0
    ds_read_b64_tr_b16 v[146:147], v119 offset:2048
    v_mfma_f32_32x32x16_bf16 v[56:71], v[88:91], v[72:75], v[56:71]
    ds_read_b128 v[148:151], v113
    ds_read_b64_tr_b16 v[152:153], v116 offset:8192
    ds_read_b64_tr_b16 v[154:155], v116 offset:10240
    v_mfma_f32_32x32x16_bf16 v[8:23], v[96:99], v[92:95], v[8:23]
    ds_read_b64_tr_b16 v[156:157], v117 offset:8192
    ds_read_b64_tr_b16 v[158:159], v117 offset:10240
    ds_read_b64_tr_b16 v[160:161], v118 offset:8192
    v_mfma_f32_32x32x16_bf16 v[24:39], v[100:103], v[92:95], v[24:39]
    ds_read_b64_tr_b16 v[162:163], v118 offset:10240
    ds_read_b64_tr_b16 v[164:165], v119 offset:8192
    ds_read_b64_tr_b16 v[166:167], v119 offset:10240
    v_mfma_f32_32x32x16_bf16 v[40:55], v[104:107], v[92:95], v[40:55]
    v_mfma_f32_32x32x16_bf16 v[56:71], v[108:111], v[92:95], v[56:71]
    s_cmp_ge_u32 s28, 4
    s_cbranch_scc1 ld_16
    s_add_u32 m0, s37, 73728
    s_mov_b32 s36, 896
    buffer_load_dwordx4 v120, s[8:11], s36 offen lds
    s_add_u32 m0, s37, 77824
    s_mov_b32 s36, 33664
    buffer_load_dwordx4 v120, s[8:11], s36 offen lds
    s_add_u32 m0, s37, 81920
    s_mov_b32 s36, 66432
    buffer_load_dwordx4 v120, s[8:11], s36 offen lds
    s_add_u32 m0, s37, 86016
    s_mov_b32 s36, 99200
    buffer_load_dwordx4 v120, s[8:11], s36 offen lds
    s_add_u32 m0, s37, 90112
    s_mov_b32 s36, 131968
    buffer_load_dwordx4 v120, s[8:11], s36 offen lds
    s_add_u32 m0, s37, 94208
    s_mov_b32 s36, 164736
    buffer_load_dwordx4 v120, s[8:11], s36 offen lds
    s_add_u32 m0, s37, 57344
    s_mov_b32 s36, 3932160
    buffer_load_dwordx4 v121, s[12:15], s36 offen lds
    s_add_u32 m0, s37, 61440
    s_mov_b32 s36, 3997696
    buffer_load_dwordx4 v121, s[12:15], s36 offen lds
    s_add_u32 m0, s37, 65536
    s_mov_b32 s36, 4063232
    buffer_load_dwordx4 v121, s[12:15], s36 offen lds
    s_add_u32 m0, s37, 69632
    s_mov_b32 s36, 4128768
    buffer_load_dwordx4 v121, s[12:15], s36 offen lds
ld_16:
    s_waitcnt vmcnt(14) lgkmcnt(0)
    s_barrier
    v_mfma_f32_32x32x16_bf16 v[8:23], v[132:135], v[128:131], v[8:23]
    v_add_u32 v116, 0xfffe8000, v116
    v_add_u32 v117, 0xfffe8000, v117
    v_add_u32 v118, 0xfffe8000, v118
    v_add_u32 v119, 0xfffe8000, v119
    ds_read_b128 v[72:75], v114
    ds_read_b64_tr_b16 v[76:77], v116 offset:0
    ds_read_b64_tr_b16 v[78:79], v116 offset:2048
    v_mfma_f32_32x32x16_bf16 v[24:39], v[136:139], v[128:131], v[24:39]
    ds_read_b64_tr_b16 v[80:81], v117 offset:0
    ds_read_b64_tr_b16 v[82:83], v117 offset:2048
    ds_read_b64_tr_b16 v[84:85], v118 offset:0
    v_mfma_f32_32x32x16_bf16 v[40:55], v[140:143], v[128:131], v[40:55]
    ds_read_b64_tr_b16 v[86:87], v118 offset:2048
    ds_read_b64_tr_b16 v[88:89], v119 offset:0
    ds_read_b64_tr_b16 v[90:91], v119 offset:2048
    v_mfma_f32_32x32x16_bf16 v[56:71], v[144:147], v[128:131], v[56:71]
    ds_read_b128 v[92:95], v115
    ds_read_b64_tr_b16 v[96:97], v116 offset:8192
    ds_read_b64_tr_b16 v[98:99], v116 offset:10240
    v_mfma_f32_32x32x16_bf16 v[8:23], v[152:155], v[148:151], v[8:23]
    ds_read_b64_tr_b16 v[100:101], v117 offset:8192
    ds_read_b64_tr_b16 v[102:103], v117 offset:10240
    ds_read_b64_tr_b16 v[104:105], v118 offset:8192
    v_mfma_f32_32x32x16_bf16 v[24:39], v[156:159], v[148:151], v[24:39]
    ds_read_b64_tr_b16 v[106:107], v118 offset:10240
    ds_read_b64_tr_b16 v[108:109], v119 offset:8192
    ds_read_b64_tr_b16 v[110:111], v119 offset:10240
    v_mfma_f32_32x32x16_bf16 v[40:55], v[160:163], v[148:151], v[40:55]
    v_mfma_f32_32x32x16_bf16 v[56:71], v[164:167], v[148:151], v[56:71]
    s_cmp_ge_u32 s28, 4
    s_cbranch_scc1 ld_17
    s_add_u32 m0, s39, 146432
    s_mov_b32 s36, 0
    buffer_load_dwordx4 v6, s[20:23], s36 offen nt lds
    s_add_u32 m0, s39, 146496
    s_nop 0
    buffer_load_dwordx4 v6, s[20:23], s36 offen offset:1024 nt lds
    s_add_u32 m0, s39, 155136
    s_mov_b32 s36, 131072
    buffer_load_dwordx4 v6, s[20:23], s36 offen nt lds
    s_add_u32 m0, s39, 155200
    s_nop 0
    buffer_load_dwordx4 v6, s[20:23], s36 offen offset:1024 nt lds
ld_17:
    s_waitcnt vmcnt(8) lgkmcnt(0)
    s_barrier
    v_mfma_f32_32x32x16_bf16 v[8:23], v[76:79], v[72:75], v[8:23]
    v_add_u32 v116, 0xe000, v116
    v_add_u32 v117, 0xe000, v117
    v_add_u32 v118, 0xe000, v118
    v_add_u32 v119, 0xe000, v119
    v_add_u32 v112, 0xffff6000, v112
    v_add_u32 v113, 0xffff6000, v113
    v_add_u32 v114, 0xffff6000, v114
    v_add_u32 v115, 0xffff6000, v115
    ds_read_b128 v[128:131], v112
    ds_read_b64_tr_b16 v[132:133], v116 offset:0
    ds_read_b64_tr_b16 v[134:135], v116 offset:2048
    v_mfma_f32_32x32x16_bf16 v[24:39], v[80:83], v[72:75], v[24:39]
    ds_read_b64_tr_b16 v[136:137], v117 offset:0
    ds_read_b64_tr_b16 v[138:139], v117 offset:2048
    ds_read_b64_tr_b16 v[140:141], v118 offset:0
    v_mfma_f32_32x32x16_bf16 v[40:55], v[84:87], v[72:75], v[40:55]
    ds_read_b64_tr_b16 v[142:143], v118 offset:2048
    ds_read_b64_tr_b16 v[144:145], v119 offset:0
    ds_read_b64_tr_b16 v[146:147], v119 offset:2048
    v_mfma_f32_32x32x16_bf16 v[56:71], v[88:91], v[72:75], v[56:71]
    ds_read_b128 v[148:151], v113
    ds_read_b64_tr_b16 v[152:153], v116 offset:8192
    ds_read_b64_tr_b16 v[154:155], v116 offset:10240
    v_mfma_f32_32x32x16_bf16 v[8:23], v[96:99], v[92:95], v[8:23]
    ds_read_b64_tr_b16 v[156:157], v117 offset:8192
    ds_read_b64_tr_b16 v[158:159], v117 offset:10240
    ds_read_b64_tr_b16 v[160:161], v118 offset:8192
    v_mfma_f32_32x32x16_bf16 v[24:39], v[100:103], v[92:95], v[24:39]
    ds_read_b64_tr_b16 v[162:163], v118 offset:10240
    ds_read_b64_tr_b16 v[164:165], v119 offset:8192
    ds_read_b64_tr_b16 v[166:167], v119 offset:10240
    v_mfma_f32_32x32x16_bf16 v[40:55], v[104:107], v[92:95], v[40:55]
    v_mfma_f32_32x32x16_bf16 v[56:71], v[108:111], v[92:95], v[56:71]
    s_cmp_ge_u32 s28, 4
    s_cbranch_scc1 ld_18
    s_add_u32 m0, s38, 33792
    s_mov_b32 s36, 16384
    buffer_load_dwordx4 v5, s[16:19], s36 offen nt lds
    s_add_u32 m0, s38, 33824
    s_nop 0
    buffer_load_dwordx4 v5, s[16:19], s36 offen offset:1024 nt lds
    s_add_u32 m0, s38, 42240
    s_mov_b32 s36, 147456
    buffer_load_dwordx4 v5, s[16:19], s36 offen nt lds
    s_add_u32 m0, s38, 42272
    s_nop 0
    buffer_load_dwordx4 v5, s[16:19], s36 offen offset:1024 nt lds
    s_add_u32 m0, s39, 129024
    s_mov_b32 s36, 8192
    buffer_load_dwordx4 v6, s[20:23], s36 offen nt lds
    s_add_u32 m0, s39, 129088
    s_nop 0
    buffer_load_dwordx4 v6, s[20:23], s36 offen offset:1024 nt lds
    s_add_u32 m0, s39, 137728
    s_mov_b32 s36, 139264
    buffer_load_dwordx4 v6, s[20:23], s36 offen nt lds
    s_add_u32 m0, s39, 137792
    s_nop 0
    buffer_load_dwordx4 v6, s[20:23], s36 offen offset:1024 nt lds
ld_18:
    s_waitcnt vmcnt(12) lgkmcnt(0)
    s_barrier
    v_mfma_f32_32x32x16_bf16 v[8:23], v[132:135], v[128:131], v[8:23]
    v_add_u32 v116, 0xffff6000, v116
    v_add_u32 v117, 0xffff6000, v117
    v_add_u32 v118, 0xffff6000, v118
    v_add_u32 v119, 0xffff6000, v119
    ds_read_b128 v[72:75], v114
    ds_read_b64_tr_b16 v[76:77], v116 offset:0
    ds_read_b64_tr_b16 v[78:79], v116 offset:2048
    v_mfma_f32_32x32x16_bf16 v[24:39], v[136:139], v[128:131], v[24:39]
    ds_read_b64_tr_b16 v[80:81], v117 offset:0
    ds_read_b64_tr_b16 v[82:83], v117 offset:2048
    ds_read_b64_tr_b16 v[84:85], v118 offset:0
    v_mfma_f32_32x32x16_bf16 v[40:55], v[140:143], v[128:131], v[40:55]
    ds_read_b64_tr_b16 v[86:87], v118 offset:2048
    ds_read_b64_tr_b16 v[88:89], v119 offset:0
    ds_read_b64_tr_b16 v[90:91], v119 offset:2048
    v_mfma_f32_32x32x16_bf16 v[56:71], v[144:147], v[128:131], v[56:71]
    ds_read_b128 v[92:95], v115
    ds_read_b64_tr_b16 v[96:97], v116 offset:8192
    ds_read_b64_tr_b16 v[98:99], v116 offset:10240
    v_mfma_f32_32x32x16_bf16 v[8:23], v[152:155], v[148:151], v[8:23]
    ds_read_b64_tr_b16 v[100:101], v117 offset:8192
    ds_read_b64_tr_b16 v[102:103], v117 offset:10240
    ds_read_b64_tr_b16 v[104:105], v118 offset:8192
    v_mfma_f32_32x32x16_bf16 v[24:39], v[156:159], v[148:151], v[24:39]
    ds_read_b64_tr_b16 v[106:107], v118 offset:10240
    ds_read_b64_tr_b16 v[108:109], v119 offset:8192
    ds_read_b64_tr_b16 v[110:111], v119 offset:10240
    v_mfma_f32_32x32x16_bf16 v[40:55], v[160:163], v[148:151], v[40:55]
    v_mfma_f32_32x32x16_bf16 v[56:71], v[164:167], v[148:151], v[56:71]
    s_cmp_ge_u32 s28, 4
    s_cbranch_scc1 ld_19
    s_add_u32 m0, s39, 111616
    s_mov_b32 s36, 16384
    buffer_load_dwordx4 v6, s[20:23], s36 offen nt lds
    s_add_u32 m0, s39, 111680
    s_nop 0
    buffer_load_dwordx4 v6, s[20:23], s36 offen offset:1024 nt lds
    s_add_u32 m0, s39, 120320
    s_mov_b32 s36, 147456
    buffer_load_dwordx4 v6, s[20:23], s36 offen nt lds
    s_add_u32 m0, s39, 120384
    s_nop 0
    buffer_load_dwordx4 v6, s[20:23], s36 offen offset:1024 nt lds
ld_19:
    s_waitcnt vmcnt(40) lgkmcnt(0)
    s_barrier
    v_mfma_f32_32x32x16_bf16 v[8:23], v[76:79], v[72:75], v[8:23]
    ds_read_b128 v[152:155], v0 offset:0
    v_mfma_f32_32x32x16_bf16 v[24:39], v[80:83], v[72:75], v[24:39]
    ds_read_b128 v[156:159], v0 offset:32
    v_mfma_f32_32x32x16_bf16 v[40:55], v[84:87], v[72:75], v[40:55]
    ds_read_b128 v[160:163], v0 offset:64
    v_mfma_f32_32x32x16_bf16 v[56:71], v[88:91], v[72:75], v[56:71]
    ds_read_b128 v[164:167], v0 offset:96
    v_mfma_f32_32x32x16_bf16 v[8:23], v[96:99], v[92:95], v[8:23]
    v_mfma_f32_32x32x16_bf16 v[24:39], v[100:103], v[92:95], v[24:39]
    v_mfma_f32_32x32x16_bf16 v[40:55], v[104:107], v[92:95], v[40:55]
    v_mfma_f32_32x32x16_bf16 v[56:71], v[108:111], v[92:95], v[56:71]
    s_nop 9
    v_pk_mul_f32 v[8:9], v[8:9], s[44:45]
    v_pk_mul_f32 v[10:11], v[10:11], s[44:45]
    v_pk_mul_f32 v[12:13], v[12:13], s[44:45]
    v_pk_mul_f32 v[14:15], v[14:15], s[44:45]
    v_pk_mul_f32 v[16:17], v[16:17], s[44:45]
    v_pk_mul_f32 v[18:19], v[18:19], s[44:45]
    v_pk_mul_f32 v[20:21], v[20:21], s[44:45]
    v_pk_mul_f32 v[22:23], v[22:23], s[44:45]
    v_cvt_pk_bf16_f32 v72, v8, v9
    v_cvt_pk_bf16_f32 v73, v10, v11
    v_cvt_pk_bf16_f32 v74, v12, v13
    v_cvt_pk_bf16_f32 v75, v14, v15
    v_cvt_pk_bf16_f32 v76, v16, v17
    v_cvt_pk_bf16_f32 v77, v18, v19
    v_cvt_pk_bf16_f32 v78, v20, v21
    v_cvt_pk_bf16_f32 v79, v22, v23
    v_pk_mul_f32 v[24:25], v[24:25], s[44:45]
    v_pk_mul_f32 v[26:27], v[26:27], s[44:45]
    v_pk_mul_f32 v[28:29], v[28:29], s[44:45]
    v_pk_mul_f32 v[30:31], v[30:31], s[44:45]
    v_pk_mul_f32 v[32:33], v[32:33], s[44:45]
    v_pk_mul_f32 v[34:35], v[34:35], s[44:45]
    v_pk_mul_f32 v[36:37], v[36:37], s[44:45]
    v_pk_mul_f32 v[38:39], v[38:39], s[44:45]
    v_cvt_pk_bf16_f32 v80, v24, v25
    v_cvt_pk_bf16_f32 v81, v26, v27
    v_cvt_pk_bf16_f32 v82, v28, v29
    v_cvt_pk_bf16_f32 v83, v30, v31
    v_cvt_pk_bf16_f32 v84, v32, v33
    v_cvt_pk_bf16_f32 v85, v34, v35
    v_cvt_pk_bf16_f32 v86, v36, v37
    v_cvt_pk_bf16_f32 v87, v38, v39
    v_pk_mul_f32 v[40:41], v[40:41], s[44:45]
    v_pk_mul_f32 v[42:43], v[42:43], s[44:45]
    v_pk_mul_f32 v[44:45], v[44:45], s[44:45]
    v_pk_mul_f32 v[46:47], v[46:47], s[44:45]
    v_pk_mul_f32 v[48:49], v[48:49], s[44:45]
    v_pk_mul_f32 v[50:51], v[50:51], s[44:45]
    v_pk_mul_f32 v[52:53], v[52:53], s[44:45]
    v_pk_mul_f32 v[54:55], v[54:55], s[44:45]
    v_cvt_pk_bf16_f32 v88, v40, v41
    v_cvt_pk_bf16_f32 v89, v42, v43
    v_cvt_pk_bf16_f32 v90, v44, v45
    v_cvt_pk_bf16_f32 v91, v46, v47
    v_cvt_pk_bf16_f32 v92, v48, v49
    v_cvt_pk_bf16_f32 v93, v50, v51
    v_cvt_pk_bf16_f32 v94, v52, v53
    v_cvt_pk_bf16_f32 v95, v54, v55
    v_pk_mul_f32 v[56:57], v[56:57], s[44:45]
    v_pk_mul_f32 v[58:59], v[58:59], s[44:45]
    v_pk_mul_f32 v[60:61], v[60:61], s[44:45]
    v_pk_mul_f32 v[62:63], v[62:63], s[44:45]
    v_pk_mul_f32 v[64:65], v[64:65], s[44:45]
    v_pk_mul_f32 v[66:67], v[66:67], s[44:45]
    v_pk_mul_f32 v[68:69], v[68:69], s[44:45]
    v_pk_mul_f32 v[70:71], v[70:71], s[44:45]
    v_cvt_pk_bf16_f32 v96, v56, v57
    v_cvt_pk_bf16_f32 v97, v58, v59
    v_cvt_pk_bf16_f32 v98, v60, v61
    v_cvt_pk_bf16_f32 v99, v62, v63
    v_cvt_pk_bf16_f32 v100, v64, v65
    v_cvt_pk_bf16_f32 v101, v66, v67
    v_cvt_pk_bf16_f32 v102, v68, v69
    v_cvt_pk_bf16_f32 v103, v70, v71
    v_mov_b32 v2, 0
    s_nop 0
    s_waitcnt lgkmcnt(3)
    v_mfma_f32_32x32x16_bf16 v[120:135], v[152:155], v[72:75], 0
    ds_read_b128 v[152:155], v0 offset:128
    s_waitcnt lgkmcnt(3)
    v_mfma_f32_32x32x16_bf16 v[120:135], v[156:159], v[76:79], v[120:135]
    ds_read_b128 v[156:159], v0 offset:160
    s_waitcnt lgkmcnt(3)
    v_mfma_f32_32x32x16_bf16 v[120:135], v[160:163], v[80:83], v[120:135]
    ds_read_b128 v[160:163], v0 offset:192
    s_waitcnt lgkmcnt(3)
    v_mfma_f32_32x32x16_bf16 v[120:135], v[164:167], v[84:87], v[120:135]
    ds_read_b128 v[164:167], v0 offset:224
    s_waitcnt lgkmcnt(3)
    v_mfma_f32_32x32x16_bf16 v[120:135], v[152:155], v[88:91], v[120:135]
    ds_read_b128 v[152:155], v0 offset:16896
    s_waitcnt lgkmcnt(3)
    v_mfma_f32_32x32x16_bf16 v[120:135], v[156:159], v[92:95], v[120:135]
    ds_read_b128 v[156:159], v0 offset:16928
    s_waitcnt lgkmcnt(3)
    v_mfma_f32_32x32x16_bf16 v[120:135], v[160:163], v[96:99], v[120:135]
    ds_read_b128 v[160:163], v0 offset:16960
    s_waitcnt lgkmcnt(3)
    v_mfma_f32_32x32x16_bf16 v[120:135], v[164:167], v[100:103], v[120:135]
    ds_read_b128 v[164:167], v0 offset:16992
    s_nop 7
    s_nop 2
    v_max3_f32 v3, v120, v121, v122
    v_max3_f32 v3, v3, v123, v124
    v_max3_f32 v3, v3, v125, v126
    v_max3_f32 v3, v3, v127, v128
    v_max3_f32 v3, v3, v129, v130
    v_max3_f32 v3, v3, v131, v132
    v_max3_f32 v3, v3, v133, v134
    v_max_f32 v3, v3, v135
    v_mov_b32 v4, v3
    s_nop 1
    v_permlane32_swap_b32 v3, v4
    s_nop 1
    v_max_f32 v3, v3, v4
    v_sub_f32 v104, 0, v3
    v_sub_f32 v105, 0, v3
    v_sub_f32 v106, 0, v3
    v_sub_f32 v107, 0, v3
    v_sub_f32 v108, 0, v3
    v_sub_f32 v109, 0, v3
    v_sub_f32 v110, 0, v3
    v_sub_f32 v111, 0, v3
    v_sub_f32 v112, 0, v3
    v_sub_f32 v113, 0, v3
    v_sub_f32 v114, 0, v3
    v_sub_f32 v115, 0, v3
    v_sub_f32 v116, 0, v3
    v_sub_f32 v117, 0, v3
    v_sub_f32 v118, 0, v3
    v_sub_f32 v119, 0, v3
    v_sub_f32 v120, v120, v3
    v_sub_f32 v121, v121, v3
    v_sub_f32 v122, v122, v3
    v_sub_f32 v123, v123, v3
    v_sub_f32 v124, v124, v3
    v_sub_f32 v125, v125, v3
    v_sub_f32 v126, v126, v3
    v_sub_f32 v127, v127, v3
    v_sub_f32 v128, v128, v3
    v_sub_f32 v129, v129, v3
    v_sub_f32 v130, v130, v3
    v_sub_f32 v131, v131, v3
    v_sub_f32 v132, v132, v3
    v_sub_f32 v133, v133, v3
    v_sub_f32 v134, v134, v3
    v_sub_f32 v135, v135, v3
    s_cmp_ge_u32 s28, 4
    s_cbranch_scc1 ld_20
    s_add_u32 m0, s38, 50688
    s_mov_b32 s36, 24576
    buffer_load_dwordx4 v5, s[16:19], s36 offen nt lds
    s_add_u32 m0, s38, 50720
    s_nop 0
    buffer_load_dwordx4 v5, s[16:19], s36 offen offset:1024 nt lds
    s_add_u32 m0, s38, 59136
    s_mov_b32 s36, 155648
    buffer_load_dwordx4 v5, s[16:19], s36 offen nt lds
    s_add_u32 m0, s38, 59168
    s_nop 0
    buffer_load_dwordx4 v5, s[16:19], s36 offen offset:1024 nt lds
    s_add_u32 m0, s39, 94208
    s_mov_b32 s36, 24576
    buffer_load_dwordx4 v6, s[20:23], s36 offen nt lds
    s_add_u32 m0, s39, 94272
    s_nop 0
    buffer_load_dwordx4 v6, s[20:23], s36 offen offset:1024 nt lds
    s_add_u32 m0, s39, 102912
    s_mov_b32 s36, 155648
    buffer_load_dwordx4 v6, s[20:23], s36 offen nt lds
    s_add_u32 m0, s39, 102976
    s_nop 0
    buffer_load_dwordx4 v6, s[20:23], s36 offen offset:1024 nt lds
ld_20:
    s_waitcnt vmcnt(16)
    s_barrier
    s_setprio 3
    s_waitcnt lgkmcnt(3)
    v_mfma_f32_32x32x16_bf16 v[136:151], v[152:155], v[72:75], v[104:119]
    ds_read_b128 v[152:155], v0 offset:17024
    s_cmp_ge_u32 s28, 4
    s_cbranch_scc1 ld_21
    s_add_u32 m0, s38, 0
    s_mov_b32 s36, 32768
    buffer_load_dwordx4 v5, s[16:19], s36 offen nt lds
    s_add_u32 m0, s38, 32
    s_nop 0
    buffer_load_dwordx4 v5, s[16:19], s36 offen offset:1024 nt lds
ld_21:
    v_exp_f32 v120, v120
    v_exp_f32 v121, v121
    v_add_f32 v2, v2, v120
    v_exp_f32 v122, v122
    s_waitcnt lgkmcnt(3)
    v_mfma_f32_32x32x16_bf16 v[136:151], v[156:159], v[76:79], v[136:151]
    ds_read_b128 v[156:159], v0 offset:17056
    v_add_f32 v2, v2, v121
    v_cvt_pk_bf16_f32 v120, v120, v121
    v_exp_f32 v123, v123
    s_waitcnt lgkmcnt(3)
    v_mfma_f32_32x32x16_bf16 v[136:151], v[160:163], v[80:83], v[136:151]
    ds_read_b128 v[160:163], v0 offset:17088
    v_add_f32 v2, v2, v122
    v_exp_f32 v124, v124
    v_add_f32 v2, v2, v123
    v_cvt_pk_bf16_f32 v121, v122, v123
    s_waitcnt lgkmcnt(3)
    v_mfma_f32_32x32x16_bf16 v[136:151], v[164:167], v[84:87], v[136:151]
    ds_read_b128 v[164:167], v0 offset:17120
    s_cmp_ge_u32 s28, 4
    s_cbranch_scc1 ld_22
    s_add_u32 m0, s38, 8448
    s_mov_b32 s36, 163840
    buffer_load_dwordx4 v5, s[16:19], s36 offen nt lds
    s_add_u32 m0, s38, 8480
    s_nop 0
    buffer_load_dwordx4 v5, s[16:19], s36 offen offset:1024 nt lds
ld_22:
    v_exp_f32 v125, v125
    v_add_f32 v2, v2, v124
    v_exp_f32 v126, v126
    s_setprio 2
    s_waitcnt lgkmcnt(3)
    v_mfma_f32_32x32x16_bf16 v[136:151], v[152:155], v[88:91], v[136:151]
    ds_read_b64_tr_b16 v[152:153], v1 offset:52224
    ds_read_b64_tr_b16 v[154:155], v1 offset:52736
    v_add_f32 v2, v2, v125
    v_cvt_pk_bf16_f32 v122, v124, v125
    v_exp_f32 v127, v127
    v_add_f32 v2, v2, v126
    s_waitcnt lgkmcnt(4)
    v_mfma_f32_32x32x16_bf16 v[136:151], v[156:159], v[92:95], v[136:151]
    ds_read_b64_tr_b16 v[156:157], v1 offset:52288
    ds_read_b64_tr_b16 v[158:159], v1 offset:52800
    v_exp_f32 v128, v128
    v_add_f32 v2, v2, v127
    v_cvt_pk_bf16_f32 v123, v126, v127
    v_exp_f32 v129, v129
    s_waitcnt lgkmcnt(5)
    v_mfma_f32_32x32x16_bf16 v[136:151], v[160:163], v[96:99], v[136:151]
    ds_read_b64_tr_b16 v[160:161], v1 offset:52352
    ds_read_b64_tr_b16 v[162:163], v1 offset:52864
    v_add_f32 v2, v2, v128
    v_exp_f32 v130, v130
    v_add_f32 v2, v2, v129
    s_waitcnt lgkmcnt(6)
    v_mfma_f32_32x32x16_bf16 v[136:151], v[164:167], v[100:103], v[136:151]
    ds_read_b64_tr_b16 v[164:165], v1 offset:52416
    ds_read_b64_tr_b16 v[166:167], v1 offset:52928
    v_cvt_pk_bf16_f32 v128, v128, v129
    v_exp_f32 v131, v131
    v_add_f32 v2, v2, v130
    v_exp_f32 v132, v132
    s_setprio 1
    s_waitcnt lgkmcnt(6)
    v_mfma_f32_32x32x16_bf16 v[8:23], v[152:155], v[120:123], 0
    ds_read_b64_tr_b16 v[152:153], v1 offset:56576
    ds_read_b64_tr_b16 v[154:155], v1 offset:57088
    v_add_f32 v2, v2, v131
    v_cvt_pk_bf16_f32 v129, v130, v131
    v_exp_f32 v133, v133
    s_waitcnt lgkmcnt(6)
    v_mfma_f32_32x32x16_bf16 v[24:39], v[156:159], v[120:123], 0
    ds_read_b64_tr_b16 v[156:157], v1 offset:56640
    ds_read_b64_tr_b16 v[158:159], v1 offset:57152
    v_add_f32 v2, v2, v132
    v_exp_f32 v134, v134
    v_add_f32 v2, v2, v133
    v_cvt_pk_bf16_f32 v130, v132, v133
    s_waitcnt lgkmcnt(6)
    v_mfma_f32_32x32x16_bf16 v[40:55], v[160:163], v[120:123], 0
    ds_read_b64_tr_b16 v[160:161], v1 offset:56704
    ds_read_b64_tr_b16 v[162:163], v1 offset:57216
    v_exp_f32 v135, v135
    v_add_f32 v2, v2, v134
    s_nop 0
    v_add_f32 v2, v2, v135
    s_waitcnt lgkmcnt(6)
    v_mfma_f32_32x32x16_bf16 v[56:71], v[164:167], v[120:123], 0
    ds_read_b64_tr_b16 v[164:165], v1 offset:56768
    ds_read_b64_tr_b16 v[166:167], v1 offset:57280
    v_cvt_pk_bf16_f32 v131, v134, v135
    s_nop 1
    s_setprio 0
    s_waitcnt lgkmcnt(6)
    v_mfma_f32_32x32x16_bf16 v[8:23], v[152:155], v[128:131], v[8:23]
    ds_read_b128 v[152:155], v0 offset:33792
    v_max3_f32 v3, v136, v137, v138
    v_max3_f32 v3, v3, v139, v140
    v_max3_f32 v3, v3, v141, v142
    s_waitcnt lgkmcnt(5)
    v_mfma_f32_32x32x16_bf16 v[24:39], v[156:159], v[128:131], v[24:39]
    ds_read_b128 v[156:159], v0 offset:33824
    v_max3_f32 v3, v3, v143, v144
    v_max3_f32 v3, v3, v145, v146
    v_max3_f32 v3, v3, v147, v148
    s_waitcnt lgkmcnt(4)
    v_mfma_f32_32x32x16_bf16 v[40:55], v[160:163], v[128:131], v[40:55]
    ds_read_b128 v[160:163], v0 offset:33856
    v_max3_f32 v3, v3, v149, v150
    v_max_f32 v3, v3, v151
    v_cmp_lt_f32 vcc, s34, v3
    s_waitcnt lgkmcnt(3)
    v_mfma_f32_32x32x16_bf16 v[56:71], v[164:167], v[128:131], v[56:71]
    ds_read_b128 v[164:167], v0 offset:33888
    s_cbranch_vccz nr_23
    s_call_b64 s[32:33], standalone__mha_block_cached__near_ridge_kernel_rescale1
nr_23:
    s_waitcnt vmcnt(8)
    s_barrier
    s_setprio 3
    s_waitcnt lgkmcnt(3)
    v_mfma_f32_32x32x16_bf16 v[120:135], v[152:155], v[72:75], v[104:119]
    ds_read_b128 v[152:155], v0 offset:33920
    s_cmp_ge_u32 s28, 4
    s_cbranch_scc1 ld_24
    s_add_u32 m0, s38, 16896
    s_mov_b32 s36, 40960
    buffer_load_dwordx4 v5, s[16:19], s36 offen nt lds
    s_add_u32 m0, s38, 16928
    s_nop 0
    buffer_load_dwordx4 v5, s[16:19], s36 offen offset:1024 nt lds
ld_24:
    v_exp_f32 v136, v136
    v_exp_f32 v137, v137
    v_add_f32 v2, v2, v136
    v_exp_f32 v138, v138
    s_waitcnt lgkmcnt(3)
    v_mfma_f32_32x32x16_bf16 v[120:135], v[156:159], v[76:79], v[120:135]
    ds_read_b128 v[156:159], v0 offset:33952
    v_add_f32 v2, v2, v137
    v_cvt_pk_bf16_f32 v136, v136, v137
    v_exp_f32 v139, v139
    s_waitcnt lgkmcnt(3)
    v_mfma_f32_32x32x16_bf16 v[120:135], v[160:163], v[80:83], v[120:135]
    ds_read_b128 v[160:163], v0 offset:33984
    v_add_f32 v2, v2, v138
    v_exp_f32 v140, v140
    v_add_f32 v2, v2, v139
    v_cvt_pk_bf16_f32 v137, v138, v139
    s_waitcnt lgkmcnt(3)
    v_mfma_f32_32x32x16_bf16 v[120:135], v[164:167], v[84:87], v[120:135]
    ds_read_b128 v[164:167], v0 offset:34016
    s_cmp_ge_u32 s28, 4
    s_cbranch_scc1 ld_25
    s_add_u32 m0, s38, 25344
    s_mov_b32 s36, 172032
    buffer_load_dwordx4 v5, s[16:19], s36 offen nt lds
    s_add_u32 m0, s38, 25376
    s_nop 0
    buffer_load_dwordx4 v5, s[16:19], s36 offen offset:1024 nt lds
ld_25:
    v_exp_f32 v141, v141
    v_add_f32 v2, v2, v140
    v_exp_f32 v142, v142
    s_setprio 2
    s_waitcnt lgkmcnt(3)
    v_mfma_f32_32x32x16_bf16 v[120:135], v[152:155], v[88:91], v[120:135]
    ds_read_b64_tr_b16 v[152:153], v1 offset:34816
    ds_read_b64_tr_b16 v[154:155], v1 offset:35328
    v_add_f32 v2, v2, v141
    v_cvt_pk_bf16_f32 v138, v140, v141
    v_exp_f32 v143, v143
    v_add_f32 v2, v2, v142
    s_waitcnt lgkmcnt(4)
    v_mfma_f32_32x32x16_bf16 v[120:135], v[156:159], v[92:95], v[120:135]
    ds_read_b64_tr_b16 v[156:157], v1 offset:34880
    ds_read_b64_tr_b16 v[158:159], v1 offset:35392
    v_exp_f32 v144, v144
    v_add_f32 v2, v2, v143
    v_cvt_pk_bf16_f32 v139, v142, v143
    v_exp_f32 v145, v145
    s_waitcnt lgkmcnt(5)
    v_mfma_f32_32x32x16_bf16 v[120:135], v[160:163], v[96:99], v[120:135]
    ds_read_b64_tr_b16 v[160:161], v1 offset:34944
    ds_read_b64_tr_b16 v[162:163], v1 offset:35456
    s_cmp_ge_u32 s28, 4
    s_cbranch_scc1 ld_26
    s_add_u32 m0, s39, 146432
    s_mov_b32 s36, 32768
    buffer_load_dwordx4 v6, s[20:23], s36 offen nt lds
    s_add_u32 m0, s39, 146496
    s_nop 0
    buffer_load_dwordx4 v6, s[20:23], s36 offen offset:1024 nt lds
ld_26:
    v_add_f32 v2, v2, v144
    v_exp_f32 v146, v146
    v_add_f32 v2, v2, v145
    s_waitcnt lgkmcnt(6)
    v_mfma_f32_32x32x16_bf16 v[120:135], v[164:167], v[100:103], v[120:135]
    ds_read_b64_tr_b16 v[164:165], v1 offset:35008
    ds_read_b64_tr_b16 v[166:167], v1 offset:35520
    v_cvt_pk_bf16_f32 v144, v144, v145
    v_exp_f32 v147, v147
    v_add_f32 v2, v2, v146
    v_exp_f32 v148, v148
    s_setprio 1
    s_waitcnt lgkmcnt(6)
    v_mfma_f32_32x32x16_bf16 v[8:23], v[152:155], v[136:139], v[8:23]
    ds_read_b64_tr_b16 v[152:153], v1 offset:39168
    ds_read_b64_tr_b16 v[154:155], v1 offset:39680
    v_add_f32 v2, v2, v147
    v_cvt_pk_bf16_f32 v145, v146, v147
    v_exp_f32 v149, v149
    s_waitcnt lgkmcnt(6)
    v_mfma_f32_32x32x16_bf16 v[24:39], v[156:159], v[136:139], v[24:39]
    ds_read_b64_tr_b16 v[156:157], v1 offset:39232
    ds_read_b64_tr_b16 v[158:159], v1 offset:39744
    s_cmp_ge_u32 s28, 4
    s_cbranch_scc1 ld_27
    s_add_u32 m0, s39, 155136
    s_mov_b32 s36, 163840
    buffer_load_dwordx4 v6, s[20:23], s36 offen nt lds
    s_add_u32 m0, s39, 155200
    s_nop 0
    buffer_load_dwordx4 v6, s[20:23], s36 offen offset:1024 nt lds
ld_27:
    v_add_f32 v2, v2, v148
    v_exp_f32 v150, v150
    v_add_f32 v2, v2, v149
    v_cvt_pk_bf16_f32 v146, v148, v149
    s_waitcnt lgkmcnt(6)
    v_mfma_f32_32x32x16_bf16 v[40:55], v[160:163], v[136:139], v[40:55]
    ds_read_b64_tr_b16 v[160:161], v1 offset:39296
    ds_read_b64_tr_b16 v[162:163], v1 offset:39808
    v_exp_f32 v151, v151
    v_add_f32 v2, v2, v150
    s_nop 0
    v_add_f32 v2, v2, v151
    s_waitcnt lgkmcnt(6)
    v_mfma_f32_32x32x16_bf16 v[56:71], v[164:167], v[136:139], v[56:71]
    ds_read_b64_tr_b16 v[164:165], v1 offset:39360
    ds_read_b64_tr_b16 v[166:167], v1 offset:39872
    v_cvt_pk_bf16_f32 v147, v150, v151
    s_nop 1
    s_setprio 0
    s_waitcnt lgkmcnt(6)
    v_mfma_f32_32x32x16_bf16 v[8:23], v[152:155], v[144:147], v[8:23]
    ds_read_b128 v[152:155], v0 offset:50688
    s_lshr_b32 s54, s41, 2
    s_and_b32 s55, s41, 3
    s_mul_i32 s43, s40, 6
    s_add_u32 s43, s43, s30
    s_lshl_b32 s43, s43, 18
    s_lshl_b32 s42, s29, 13
    s_add_u32 s43, s43, s42
    s_add_u32 s42, s55, 0
    s_and_b32 s42, s42, 3
    s_lshl2_add_u32 s42, s54, s42
    s_lshl_b32 s50, s42, 14
    s_add_u32 s50, s50, s43
    s_lshl_b32 s46, s42, 18
    s_cmp_le_u32 s55, 0
    s_cselect_b32 s42, 1, 0
    s_lshl2_add_u32 s42, s54, s42
    s_lshl_b32 s51, s42, 14
    s_add_u32 s51, s51, s43
    s_lshl_b32 s47, s42, 18
    s_cmp_le_u32 s55, 1
    s_cselect_b32 s42, 2, 1
    s_lshl2_add_u32 s42, s54, s42
    s_lshl_b32 s52, s42, 14
    s_add_u32 s52, s52, s43
    s_lshl_b32 s48, s42, 18
    s_cmp_le_u32 s55, 2
    s_cselect_b32 s42, 3, 2
    s_lshl2_add_u32 s42, s54, s42
    s_lshl_b32 s53, s42, 14
    s_add_u32 s53, s53, s43
    s_lshl_b32 s49, s42, 18
    s_lshl_b32 s42, s55, 8
    s_add_u32 s46, s46, s42
    s_add_u32 s47, s47, s42
    s_add_u32 s48, s48, s42
    s_add_u32 s49, s49, s42
    s_lshl_b32 s56, s28, 11
    s_lshl_b32 s42, s40, 4
    s_add_u32 s42, s42, s41
    s_mul_i32 s42, s42, 12
    s_add_u32 s42, s42, s28
    s_lshl_b32 s42, s42, 12
    s_add_u32 s59, s42, 33554432
    s_mov_b32 s8, s92
    s_mov_b32 s9, s93
    s_mov_b32 s10, 4194304
    s_mov_b32 s11, 0x00020000
    s_mov_b32 s12, s94
    s_mov_b32 s13, s95
    s_mov_b32 s14, 3145728
    s_mov_b32 s15, 0x00020000
    v_max3_f32 v3, v120, v121, v122
    v_max3_f32 v3, v3, v123, v124
    v_max3_f32 v3, v3, v125, v126
    s_waitcnt lgkmcnt(5)
    v_mfma_f32_32x32x16_bf16 v[24:39], v[156:159], v[144:147], v[24:39]
    ds_read_b128 v[156:159], v0 offset:50720
    v_max3_f32 v3, v3, v127, v128
    v_max3_f32 v3, v3, v129, v130
    v_max3_f32 v3, v3, v131, v132
    s_waitcnt lgkmcnt(4)
    v_mfma_f32_32x32x16_bf16 v[40:55], v[160:163], v[144:147], v[40:55]
    ds_read_b128 v[160:163], v0 offset:50752
    v_max3_f32 v3, v3, v133, v134
    v_max_f32 v3, v3, v135
    v_cmp_lt_f32 vcc, s34, v3
    s_waitcnt lgkmcnt(3)
    v_mfma_f32_32x32x16_bf16 v[56:71], v[164:167], v[144:147], v[56:71]
    ds_read_b128 v[164:167], v0 offset:50784
    s_cbranch_vccz nr_28
    s_call_b64 s[32:33], standalone__mha_block_cached__near_ridge_kernel_rescale0
nr_28:
    s_waitcnt vmcnt(8)
    s_barrier
    s_setprio 3
    s_waitcnt lgkmcnt(3)
    v_mfma_f32_32x32x16_bf16 v[136:151], v[152:155], v[72:75], v[104:119]
    ds_read_b128 v[152:155], v0 offset:50816
    s_cmp_ge_u32 s28, 4
    s_cbranch_scc1 ld_29
    s_add_u32 m0, s38, 33792
    s_mov_b32 s36, 49152
    buffer_load_dwordx4 v5, s[16:19], s36 offen nt lds
    s_add_u32 m0, s38, 33824
    s_nop 0
    buffer_load_dwordx4 v5, s[16:19], s36 offen offset:1024 nt lds
ld_29:
    v_exp_f32 v120, v120
    v_exp_f32 v121, v121
    v_add_f32 v2, v2, v120
    v_exp_f32 v122, v122
    s_waitcnt lgkmcnt(3)
    v_mfma_f32_32x32x16_bf16 v[136:151], v[156:159], v[76:79], v[136:151]
    ds_read_b128 v[156:159], v0 offset:50848
    v_add_f32 v2, v2, v121
    v_cvt_pk_bf16_f32 v120, v120, v121
    v_exp_f32 v123, v123
    s_waitcnt lgkmcnt(3)
    v_mfma_f32_32x32x16_bf16 v[136:151], v[160:163], v[80:83], v[136:151]
    ds_read_b128 v[160:163], v0 offset:50880
    v_add_f32 v2, v2, v122
    v_exp_f32 v124, v124
    v_add_f32 v2, v2, v123
    v_cvt_pk_bf16_f32 v121, v122, v123
    s_waitcnt lgkmcnt(3)
    v_mfma_f32_32x32x16_bf16 v[136:151], v[164:167], v[84:87], v[136:151]
    ds_read_b128 v[164:167], v0 offset:50912
    s_cmp_ge_u32 s28, 4
    s_cbranch_scc1 ld_30
    s_add_u32 m0, s38, 42240
    s_mov_b32 s36, 180224
    buffer_load_dwordx4 v5, s[16:19], s36 offen nt lds
    s_add_u32 m0, s38, 42272
    s_nop 0
    buffer_load_dwordx4 v5, s[16:19], s36 offen offset:1024 nt lds
ld_30:
    v_exp_f32 v125, v125
    v_add_f32 v2, v2, v124
    v_exp_f32 v126, v126
    s_setprio 2
    s_waitcnt lgkmcnt(3)
    v_mfma_f32_32x32x16_bf16 v[136:151], v[152:155], v[88:91], v[136:151]
    ds_read_b64_tr_b16 v[152:153], v1 offset:17408
    ds_read_b64_tr_b16 v[154:155], v1 offset:17920
    v_add_f32 v2, v2, v125
    v_cvt_pk_bf16_f32 v122, v124, v125
    v_exp_f32 v127, v127
    v_add_f32 v2, v2, v126
    s_waitcnt lgkmcnt(4)
    v_mfma_f32_32x32x16_bf16 v[136:151], v[156:159], v[92:95], v[136:151]
    ds_read_b64_tr_b16 v[156:157], v1 offset:17472
    ds_read_b64_tr_b16 v[158:159], v1 offset:17984
    v_exp_f32 v128, v128
    v_add_f32 v2, v2, v127
    v_cvt_pk_bf16_f32 v123, v126, v127
    v_exp_f32 v129, v129
    s_waitcnt lgkmcnt(5)
    v_mfma_f32_32x32x16_bf16 v[136:151], v[160:163], v[96:99], v[136:151]
    ds_read_b64_tr_b16 v[160:161], v1 offset:17536
    ds_read_b64_tr_b16 v[162:163], v1 offset:18048
    s_cmp_ge_u32 s28, 4
    s_cbranch_scc1 ld_31
    s_add_u32 m0, s39, 129024
    s_mov_b32 s36, 40960
    buffer_load_dwordx4 v6, s[20:23], s36 offen nt lds
    s_add_u32 m0, s39, 129088
    s_nop 0
    buffer_load_dwordx4 v6, s[20:23], s36 offen offset:1024 nt lds
ld_31:
    v_add_f32 v2, v2, v128
    v_exp_f32 v130, v130
    v_add_f32 v2, v2, v129
    s_waitcnt lgkmcnt(6)
    v_mfma_f32_32x32x16_bf16 v[136:151], v[164:167], v[100:103], v[136:151]
    ds_read_b64_tr_b16 v[164:165], v1 offset:17600
    ds_read_b64_tr_b16 v[166:167], v1 offset:18112
    v_cvt_pk_bf16_f32 v128, v128, v129
    v_exp_f32 v131, v131
    v_add_f32 v2, v2, v130
    v_exp_f32 v132, v132
    s_setprio 1
    s_waitcnt lgkmcnt(6)
    v_mfma_f32_32x32x16_bf16 v[8:23], v[152:155], v[120:123], v[8:23]
    ds_read_b64_tr_b16 v[152:153], v1 offset:21760
    ds_read_b64_tr_b16 v[154:155], v1 offset:22272
    v_add_f32 v2, v2, v131
    v_cvt_pk_bf16_f32 v129, v130, v131
    v_exp_f32 v133, v133
    s_waitcnt lgkmcnt(6)
    v_mfma_f32_32x32x16_bf16 v[24:39], v[156:159], v[120:123], v[24:39]
    ds_read_b64_tr_b16 v[156:157], v1 offset:21824
    ds_read_b64_tr_b16 v[158:159], v1 offset:22336
    s_cmp_ge_u32 s28, 4
    s_cbranch_scc1 ld_32
    s_add_u32 m0, s39, 137728
    s_mov_b32 s36, 172032
    buffer_load_dwordx4 v6, s[20:23], s36 offen nt lds
    s_add_u32 m0, s39, 137792
    s_nop 0
    buffer_load_dwordx4 v6, s[20:23], s36 offen offset:1024 nt lds
ld_32:
    v_add_f32 v2, v2, v132
    v_exp_f32 v134, v134
    v_add_f32 v2, v2, v133
    v_cvt_pk_bf16_f32 v130, v132, v133
    s_waitcnt lgkmcnt(6)
    v_mfma_f32_32x32x16_bf16 v[40:55], v[160:163], v[120:123], v[40:55]
    ds_read_b64_tr_b16 v[160:161], v1 offset:21888
    ds_read_b64_tr_b16 v[162:163], v1 offset:22400
    v_exp_f32 v135, v135
    v_add_f32 v2, v2, v134
    s_nop 0
    v_add_f32 v2, v2, v135
    s_waitcnt lgkmcnt(6)
    v_mfma_f32_32x32x16_bf16 v[56:71], v[164:167], v[120:123], v[56:71]
    ds_read_b64_tr_b16 v[164:165], v1 offset:21952
    ds_read_b64_tr_b16 v[166:167], v1 offset:22464
    v_cvt_pk_bf16_f32 v131, v134, v135
    s_nop 1
    s_setprio 0
    s_waitcnt lgkmcnt(6)
    v_mfma_f32_32x32x16_bf16 v[8:23], v[152:155], v[128:131], v[8:23]
    ds_read_b128 v[152:155], v0 offset:0
    v_max3_f32 v3, v136, v137, v138
    v_max3_f32 v3, v3, v139, v140
    v_max3_f32 v3, v3, v141, v142
    s_waitcnt lgkmcnt(5)
    v_mfma_f32_32x32x16_bf16 v[24:39], v[156:159], v[128:131], v[24:39]
    ds_read_b128 v[156:159], v0 offset:32
    v_max3_f32 v3, v3, v143, v144
    v_max3_f32 v3, v3, v145, v146
    v_max3_f32 v3, v3, v147, v148
    s_waitcnt lgkmcnt(4)
    v_mfma_f32_32x32x16_bf16 v[40:55], v[160:163], v[128:131], v[40:55]
    ds_read_b128 v[160:163], v0 offset:64
    v_max3_f32 v3, v3, v149, v150
    v_max_f32 v3, v3, v151
    v_cmp_lt_f32 vcc, s34, v3
    s_waitcnt lgkmcnt(3)
    v_mfma_f32_32x32x16_bf16 v[56:71], v[164:167], v[128:131], v[56:71]
    ds_read_b128 v[164:167], v0 offset:96
    s_cbranch_vccz nr_33
    s_call_b64 s[32:33], standalone__mha_block_cached__near_ridge_kernel_rescale1
nr_33:
    s_waitcnt vmcnt(12)
    s_barrier
    s_setprio 3
    s_waitcnt lgkmcnt(3)
    v_mfma_f32_32x32x16_bf16 v[120:135], v[152:155], v[72:75], v[104:119]
    ds_read_b128 v[152:155], v0 offset:128
    s_cmp_ge_u32 s28, 4
    s_cbranch_scc1 ld_34
    s_add_u32 m0, s38, 50688
    s_mov_b32 s36, 57344
    buffer_load_dwordx4 v5, s[16:19], s36 offen nt lds
    s_add_u32 m0, s38, 50720
    s_nop 0
    buffer_load_dwordx4 v5, s[16:19], s36 offen offset:1024 nt lds
ld_34:
    v_exp_f32 v136, v136
    v_exp_f32 v137, v137
    v_add_f32 v2, v2, v136
    v_exp_f32 v138, v138
    s_waitcnt lgkmcnt(3)
    v_mfma_f32_32x32x16_bf16 v[120:135], v[156:159], v[76:79], v[120:135]
    ds_read_b128 v[156:159], v0 offset:160
    v_add_f32 v2, v2, v137
    v_cvt_pk_bf16_f32 v136, v136, v137
    v_exp_f32 v139, v139
    s_waitcnt lgkmcnt(3)
    v_mfma_f32_32x32x16_bf16 v[120:135], v[160:163], v[80:83], v[120:135]
    ds_read_b128 v[160:163], v0 offset:192
    v_add_f32 v2, v2, v138
    v_exp_f32 v140, v140
    v_add_f32 v2, v2, v139
    v_cvt_pk_bf16_f32 v137, v138, v139
    s_waitcnt lgkmcnt(3)
    v_mfma_f32_32x32x16_bf16 v[120:135], v[164:167], v[84:87], v[120:135]
    ds_read_b128 v[164:167], v0 offset:224
    s_cmp_ge_u32 s28, 4
    s_cbranch_scc1 ld_35
    s_add_u32 m0, s38, 59136
    s_mov_b32 s36, 188416
    buffer_load_dwordx4 v5, s[16:19], s36 offen nt lds
    s_add_u32 m0, s38, 59168
    s_nop 0
    buffer_load_dwordx4 v5, s[16:19], s36 offen offset:1024 nt lds
ld_35:
    v_exp_f32 v141, v141
    v_add_f32 v2, v2, v140
    v_exp_f32 v142, v142
    s_setprio 2
    s_waitcnt lgkmcnt(3)
    v_mfma_f32_32x32x16_bf16 v[120:135], v[152:155], v[88:91], v[120:135]
    ds_read_b64_tr_b16 v[152:153], v1 offset:0
    ds_read_b64_tr_b16 v[154:155], v1 offset:512
    v_add_f32 v2, v2, v141
    v_cvt_pk_bf16_f32 v138, v140, v141
    v_exp_f32 v143, v143
    v_add_f32 v2, v2, v142
    s_waitcnt lgkmcnt(4)
    v_mfma_f32_32x32x16_bf16 v[120:135], v[156:159], v[92:95], v[120:135]
    ds_read_b64_tr_b16 v[156:157], v1 offset:64
    ds_read_b64_tr_b16 v[158:159], v1 offset:576
    v_exp_f32 v144, v144
    v_add_f32 v2, v2, v143
    v_cvt_pk_bf16_f32 v139, v142, v143
    v_exp_f32 v145, v145
    s_waitcnt lgkmcnt(5)
    v_mfma_f32_32x32x16_bf16 v[120:135], v[160:163], v[96:99], v[120:135]
    ds_read_b64_tr_b16 v[160:161], v1 offset:128
    ds_read_b64_tr_b16 v[162:163], v1 offset:640
    s_cmp_ge_u32 s28, 4
    s_cbranch_scc1 ld_36
    s_add_u32 m0, s39, 111616
    s_mov_b32 s36, 49152
    buffer_load_dwordx4 v6, s[20:23], s36 offen nt lds
    s_add_u32 m0, s39, 111680
    s_nop 0
    buffer_load_dwordx4 v6, s[20:23], s36 offen offset:1024 nt lds
ld_36:
    v_add_f32 v2, v2, v144
    v_exp_f32 v146, v146
    v_add_f32 v2, v2, v145
    s_waitcnt lgkmcnt(6)
    v_mfma_f32_32x32x16_bf16 v[120:135], v[164:167], v[100:103], v[120:135]
    ds_read_b64_tr_b16 v[164:165], v1 offset:192
    ds_read_b64_tr_b16 v[166:167], v1 offset:704
    v_cvt_pk_bf16_f32 v144, v144, v145
    v_exp_f32 v147, v147
    v_add_f32 v2, v2, v146
    v_exp_f32 v148, v148
    s_setprio 1
    s_waitcnt lgkmcnt(6)
    v_mfma_f32_32x32x16_bf16 v[8:23], v[152:155], v[136:139], v[8:23]
    ds_read_b64_tr_b16 v[152:153], v1 offset:4352
    ds_read_b64_tr_b16 v[154:155], v1 offset:4864
    v_add_f32 v2, v2, v147
    v_cvt_pk_bf16_f32 v145, v146, v147
    v_exp_f32 v149, v149
    s_waitcnt lgkmcnt(6)
    v_mfma_f32_32x32x16_bf16 v[24:39], v[156:159], v[136:139], v[24:39]
    ds_read_b64_tr_b16 v[156:157], v1 offset:4416
    ds_read_b64_tr_b16 v[158:159], v1 offset:4928
    s_cmp_ge_u32 s28, 4
    s_cbranch_scc1 ld_37
    s_add_u32 m0, s39, 120320
    s_mov_b32 s36, 180224
    buffer_load_dwordx4 v6, s[20:23], s36 offen nt lds
    s_add_u32 m0, s39, 120384
    s_nop 0
    buffer_load_dwordx4 v6, s[20:23], s36 offen offset:1024 nt lds
ld_37:
    v_add_f32 v2, v2, v148
    v_exp_f32 v150, v150
    v_add_f32 v2, v2, v149
    v_cvt_pk_bf16_f32 v146, v148, v149
    s_waitcnt lgkmcnt(6)
    v_mfma_f32_32x32x16_bf16 v[40:55], v[160:163], v[136:139], v[40:55]
    ds_read_b64_tr_b16 v[160:161], v1 offset:4480
    ds_read_b64_tr_b16 v[162:163], v1 offset:4992
    v_exp_f32 v151, v151
    v_add_f32 v2, v2, v150
    s_nop 0
    v_add_f32 v2, v2, v151
    s_waitcnt lgkmcnt(6)
    v_mfma_f32_32x32x16_bf16 v[56:71], v[164:167], v[136:139], v[56:71]
    ds_read_b64_tr_b16 v[164:165], v1 offset:4544
    ds_read_b64_tr_b16 v[166:167], v1 offset:5056
    v_cvt_pk_bf16_f32 v147, v150, v151
    s_nop 1
    s_setprio 0
    s_waitcnt lgkmcnt(6)
    v_mfma_f32_32x32x16_bf16 v[8:23], v[152:155], v[144:147], v[8:23]
    ds_read_b128 v[152:155], v0 offset:16896
    v_max3_f32 v3, v120, v121, v122
    v_max3_f32 v3, v3, v123, v124
    v_max3_f32 v3, v3, v125, v126
    s_waitcnt lgkmcnt(5)
    v_mfma_f32_32x32x16_bf16 v[24:39], v[156:159], v[144:147], v[24:39]
    ds_read_b128 v[156:159], v0 offset:16928
    v_max3_f32 v3, v3, v127, v128
    v_max3_f32 v3, v3, v129, v130
    v_max3_f32 v3, v3, v131, v132
    s_waitcnt lgkmcnt(4)
    v_mfma_f32_32x32x16_bf16 v[40:55], v[160:163], v[144:147], v[40:55]
    ds_read_b128 v[160:163], v0 offset:16960
    v_max3_f32 v3, v3, v133, v134
    v_max_f32 v3, v3, v135
    v_cmp_lt_f32 vcc, s34, v3
    s_waitcnt lgkmcnt(3)
    v_mfma_f32_32x32x16_bf16 v[56:71], v[164:167], v[144:147], v[56:71]
    ds_read_b128 v[164:167], v0 offset:16992
    s_cbranch_vccz nr_38
    s_call_b64 s[32:33], standalone__mha_block_cached__near_ridge_kernel_rescale0
nr_38:
    s_waitcnt vmcnt(12)
    s_barrier
    s_setprio 3
    s_waitcnt lgkmcnt(3)
    v_mfma_f32_32x32x16_bf16 v[136:151], v[152:155], v[72:75], v[104:119]
    ds_read_b128 v[152:155], v0 offset:17024
    s_cmp_ge_u32 s28, 4
    s_cbranch_scc1 ld_39
    s_add_u32 m0, s38, 0
    s_mov_b32 s36, 65536
    buffer_load_dwordx4 v5, s[16:19], s36 offen nt lds
    s_add_u32 m0, s38, 32
    s_nop 0
    buffer_load_dwordx4 v5, s[16:19], s36 offen offset:1024 nt lds
ld_39:
    v_exp_f32 v120, v120
    v_exp_f32 v121, v121
    v_add_f32 v2, v2, v120
    v_exp_f32 v122, v122
    s_waitcnt lgkmcnt(3)
    v_mfma_f32_32x32x16_bf16 v[136:151], v[156:159], v[76:79], v[136:151]
    ds_read_b128 v[156:159], v0 offset:17056
    v_add_f32 v2, v2, v121
    v_cvt_pk_bf16_f32 v120, v120, v121
    v_exp_f32 v123, v123
    s_waitcnt lgkmcnt(3)
    v_mfma_f32_32x32x16_bf16 v[136:151], v[160:163], v[80:83], v[136:151]
    ds_read_b128 v[160:163], v0 offset:17088
    v_add_f32 v2, v2, v122
    v_exp_f32 v124, v124
    v_add_f32 v2, v2, v123
    v_cvt_pk_bf16_f32 v121, v122, v123
    s_waitcnt lgkmcnt(3)
    v_mfma_f32_32x32x16_bf16 v[136:151], v[164:167], v[84:87], v[136:151]
    ds_read_b128 v[164:167], v0 offset:17120
    s_cmp_ge_u32 s28, 4
    s_cbranch_scc1 ld_40
    s_add_u32 m0, s38, 8448
    s_mov_b32 s36, 196608
    buffer_load_dwordx4 v5, s[16:19], s36 offen nt lds
    s_add_u32 m0, s38, 8480
    s_nop 0
    buffer_load_dwordx4 v5, s[16:19], s36 offen offset:1024 nt lds
ld_40:
    v_exp_f32 v125, v125
    v_add_f32 v2, v2, v124
    v_exp_f32 v126, v126
    s_setprio 2
    s_waitcnt lgkmcnt(3)
    v_mfma_f32_32x32x16_bf16 v[136:151], v[152:155], v[88:91], v[136:151]
    ds_read_b64_tr_b16 v[152:153], v1 offset:52224
    ds_read_b64_tr_b16 v[154:155], v1 offset:52736
    v_add_f32 v2, v2, v125
    v_cvt_pk_bf16_f32 v122, v124, v125
    v_exp_f32 v127, v127
    v_add_f32 v2, v2, v126
    s_waitcnt lgkmcnt(4)
    v_mfma_f32_32x32x16_bf16 v[136:151], v[156:159], v[92:95], v[136:151]
    ds_read_b64_tr_b16 v[156:157], v1 offset:52288
    ds_read_b64_tr_b16 v[158:159], v1 offset:52800
    v_exp_f32 v128, v128
    v_add_f32 v2, v2, v127
    v_cvt_pk_bf16_f32 v123, v126, v127
    v_exp_f32 v129, v129
    s_waitcnt lgkmcnt(5)
    v_mfma_f32_32x32x16_bf16 v[136:151], v[160:163], v[96:99], v[136:151]
    ds_read_b64_tr_b16 v[160:161], v1 offset:52352
    ds_read_b64_tr_b16 v[162:163], v1 offset:52864
    s_cmp_ge_u32 s28, 4
    s_cbranch_scc1 ld_41
    s_add_u32 m0, s39, 94208
    s_mov_b32 s36, 57344
    buffer_load_dwordx4 v6, s[20:23], s36 offen nt lds
    s_add_u32 m0, s39, 94272
    s_nop 0
    buffer_load_dwordx4 v6, s[20:23], s36 offen offset:1024 nt lds
ld_41:
    v_add_f32 v2, v2, v128
    v_exp_f32 v130, v130
    v_add_f32 v2, v2, v129
    s_waitcnt lgkmcnt(6)
    v_mfma_f32_32x32x16_bf16 v[136:151], v[164:167], v[100:103], v[136:151]
    ds_read_b64_tr_b16 v[164:165], v1 offset:52416
    ds_read_b64_tr_b16 v[166:167], v1 offset:52928
    v_cvt_pk_bf16_f32 v128, v128, v129
    v_exp_f32 v131, v131
    v_add_f32 v2, v2, v130
    v_exp_f32 v132, v132
    s_setprio 1
    s_waitcnt lgkmcnt(6)
    v_mfma_f32_32x32x16_bf16 v[8:23], v[152:155], v[120:123], v[8:23]
    ds_read_b64_tr_b16 v[152:153], v1 offset:56576
    ds_read_b64_tr_b16 v[154:155], v1 offset:57088
    v_add_f32 v2, v2, v131
    v_cvt_pk_bf16_f32 v129, v130, v131
    v_exp_f32 v133, v133
    s_waitcnt lgkmcnt(6)
    v_mfma_f32_32x32x16_bf16 v[24:39], v[156:159], v[120:123], v[24:39]
    ds_read_b64_tr_b16 v[156:157], v1 offset:56640
    ds_read_b64_tr_b16 v[158:159], v1 offset:57152
    s_cmp_ge_u32 s28, 4
    s_cbranch_scc1 ld_42
    s_add_u32 m0, s39, 102912
    s_mov_b32 s36, 188416
    buffer_load_dwordx4 v6, s[20:23], s36 offen nt lds
    s_add_u32 m0, s39, 102976
    s_nop 0
    buffer_load_dwordx4 v6, s[20:23], s36 offen offset:1024 nt lds
ld_42:
    v_add_f32 v2, v2, v132
    v_exp_f32 v134, v134
    v_add_f32 v2, v2, v133
    v_cvt_pk_bf16_f32 v130, v132, v133
    s_waitcnt lgkmcnt(6)
    v_mfma_f32_32x32x16_bf16 v[40:55], v[160:163], v[120:123], v[40:55]
    ds_read_b64_tr_b16 v[160:161], v1 offset:56704
    ds_read_b64_tr_b16 v[162:163], v1 offset:57216
    v_exp_f32 v135, v135
    v_add_f32 v2, v2, v134
    s_nop 0
    v_add_f32 v2, v2, v135
    s_waitcnt lgkmcnt(6)
    v_mfma_f32_32x32x16_bf16 v[56:71], v[164:167], v[120:123], v[56:71]
    ds_read_b64_tr_b16 v[164:165], v1 offset:56768
    ds_read_b64_tr_b16 v[166:167], v1 offset:57280
    v_cvt_pk_bf16_f32 v131, v134, v135
    s_nop 1
    s_setprio 0
    s_waitcnt lgkmcnt(6)
    v_mfma_f32_32x32x16_bf16 v[8:23], v[152:155], v[128:131], v[8:23]
    ds_read_b128 v[152:155], v0 offset:33792
    s_lshr_b32 s42, s28, 2
    s_cmp_lg_u32 s42, 1
    s_cbranch_scc1 wt_43
    s_lshl_b32 s36, s2, 14
    s_and_b32 s42, s28, 3
    s_lshl_b32 s42, s42, 12
    s_add_u32 s36, s36, s42
    v_lshlrev_b32 v5, 6, v7
    buffer_load_dword v6, v5, s[8:11], s36 offen
wt_43:
    v_max3_f32 v3, v136, v137, v138
    v_max3_f32 v3, v3, v139, v140
    v_max3_f32 v3, v3, v141, v142
    s_waitcnt lgkmcnt(5)
    v_mfma_f32_32x32x16_bf16 v[24:39], v[156:159], v[128:131], v[24:39]
    ds_read_b128 v[156:159], v0 offset:33824
    v_max3_f32 v3, v3, v143, v144
    v_max3_f32 v3, v3, v145, v146
    v_max3_f32 v3, v3, v147, v148
    s_waitcnt lgkmcnt(4)
    v_mfma_f32_32x32x16_bf16 v[40:55], v[160:163], v[128:131], v[40:55]
    ds_read_b128 v[160:163], v0 offset:33856
    v_max3_f32 v3, v3, v149, v150
    v_max_f32 v3, v3, v151
    v_cmp_lt_f32 vcc, s34, v3
    s_waitcnt lgkmcnt(3)
    v_mfma_f32_32x32x16_bf16 v[56:71], v[164:167], v[128:131], v[56:71]
    ds_read_b128 v[164:167], v0 offset:33888
    s_cbranch_vccz nr_44
    s_call_b64 s[32:33], standalone__mha_block_cached__near_ridge_kernel_rescale1
nr_44:
    s_waitcnt vmcnt(12)
    s_barrier
    s_setprio 3
    s_waitcnt lgkmcnt(3)
    v_mfma_f32_32x32x16_bf16 v[120:135], v[152:155], v[72:75], v[104:119]
    ds_read_b128 v[152:155], v0 offset:33920
    s_cmp_ge_u32 s28, 4
    s_cbranch_scc1 ld_45
    s_add_u32 m0, s38, 16896
    s_mov_b32 s36, 73728
    buffer_load_dwordx4 v5, s[16:19], s36 offen nt lds
    s_add_u32 m0, s38, 16928
    s_nop 0
    buffer_load_dwordx4 v5, s[16:19], s36 offen offset:1024 nt lds
ld_45:
    v_exp_f32 v136, v136
    v_exp_f32 v137, v137
    v_add_f32 v2, v2, v136
    v_exp_f32 v138, v138
    s_waitcnt lgkmcnt(3)
    v_mfma_f32_32x32x16_bf16 v[120:135], v[156:159], v[76:79], v[120:135]
    ds_read_b128 v[156:159], v0 offset:33952
    v_add_f32 v2, v2, v137
    v_cvt_pk_bf16_f32 v136, v136, v137
    v_exp_f32 v139, v139
    s_waitcnt lgkmcnt(3)
    v_mfma_f32_32x32x16_bf16 v[120:135], v[160:163], v[80:83], v[120:135]
    ds_read_b128 v[160:163], v0 offset:33984
    v_add_f32 v2, v2, v138
    v_exp_f32 v140, v140
    v_add_f32 v2, v2, v139
    v_cvt_pk_bf16_f32 v137, v138, v139
    s_waitcnt lgkmcnt(3)
    v_mfma_f32_32x32x16_bf16 v[120:135], v[164:167], v[84:87], v[120:135]
    ds_read_b128 v[164:167], v0 offset:34016
    s_cmp_ge_u32 s28, 4
    s_cbranch_scc1 ld_46
    s_add_u32 m0, s38, 25344
    s_mov_b32 s36, 204800
    buffer_load_dwordx4 v5, s[16:19], s36 offen nt lds
    s_add_u32 m0, s38, 25376
    s_nop 0
    buffer_load_dwordx4 v5, s[16:19], s36 offen offset:1024 nt lds
ld_46:
    v_exp_f32 v141, v141
    v_add_f32 v2, v2, v140
    v_exp_f32 v142, v142
    s_setprio 2
    s_waitcnt lgkmcnt(3)
    v_mfma_f32_32x32x16_bf16 v[120:135], v[152:155], v[88:91], v[120:135]
    ds_read_b64_tr_b16 v[152:153], v1 offset:34816
    ds_read_b64_tr_b16 v[154:155], v1 offset:35328
    v_add_f32 v2, v2, v141
    v_cvt_pk_bf16_f32 v138, v140, v141
    v_exp_f32 v143, v143
    v_add_f32 v2, v2, v142
    s_waitcnt lgkmcnt(4)
    v_mfma_f32_32x32x16_bf16 v[120:135], v[156:159], v[92:95], v[120:135]
    ds_read_b64_tr_b16 v[156:157], v1 offset:34880
    ds_read_b64_tr_b16 v[158:159], v1 offset:35392
    v_exp_f32 v144, v144
    v_add_f32 v2, v2, v143
    v_cvt_pk_bf16_f32 v139, v142, v143
    v_exp_f32 v145, v145
    s_waitcnt lgkmcnt(5)
    v_mfma_f32_32x32x16_bf16 v[120:135], v[160:163], v[96:99], v[120:135]
    ds_read_b64_tr_b16 v[160:161], v1 offset:34944
    ds_read_b64_tr_b16 v[162:163], v1 offset:35456
    s_cmp_ge_u32 s28, 4
    s_cbranch_scc1 ld_47
    s_add_u32 m0, s39, 146432
    s_mov_b32 s36, 65536
    buffer_load_dwordx4 v6, s[20:23], s36 offen nt lds
    s_add_u32 m0, s39, 146496
    s_nop 0
    buffer_load_dwordx4 v6, s[20:23], s36 offen offset:1024 nt lds
ld_47:
    v_add_f32 v2, v2, v144
    v_exp_f32 v146, v146
    v_add_f32 v2, v2, v145
    s_waitcnt lgkmcnt(6)
    v_mfma_f32_32x32x16_bf16 v[120:135], v[164:167], v[100:103], v[120:135]
    ds_read_b64_tr_b16 v[164:165], v1 offset:35008
    ds_read_b64_tr_b16 v[166:167], v1 offset:35520
    v_cvt_pk_bf16_f32 v144, v144, v145
    v_exp_f32 v147, v147
    v_add_f32 v2, v2, v146
    v_exp_f32 v148, v148
    s_setprio 1
    s_waitcnt lgkmcnt(6)
    v_mfma_f32_32x32x16_bf16 v[8:23], v[152:155], v[136:139], v[8:23]
    ds_read_b64_tr_b16 v[152:153], v1 offset:39168
    ds_read_b64_tr_b16 v[154:155], v1 offset:39680
    v_add_f32 v2, v2, v147
    v_cvt_pk_bf16_f32 v145, v146, v147
    v_exp_f32 v149, v149
    s_waitcnt lgkmcnt(6)
    v_mfma_f32_32x32x16_bf16 v[24:39], v[156:159], v[136:139], v[24:39]
    ds_read_b64_tr_b16 v[156:157], v1 offset:39232
    ds_read_b64_tr_b16 v[158:159], v1 offset:39744
    s_cmp_ge_u32 s28, 4
    s_cbranch_scc1 ld_48
    s_add_u32 m0, s39, 155136
    s_mov_b32 s36, 196608
    buffer_load_dwordx4 v6, s[20:23], s36 offen nt lds
    s_add_u32 m0, s39, 155200
    s_nop 0
    buffer_load_dwordx4 v6, s[20:23], s36 offen offset:1024 nt lds
ld_48:
    v_add_f32 v2, v2, v148
    v_exp_f32 v150, v150
    v_add_f32 v2, v2, v149
    v_cvt_pk_bf16_f32 v146, v148, v149
    s_waitcnt lgkmcnt(6)
    v_mfma_f32_32x32x16_bf16 v[40:55], v[160:163], v[136:139], v[40:55]
    ds_read_b64_tr_b16 v[160:161], v1 offset:39296
    ds_read_b64_tr_b16 v[162:163], v1 offset:39808
    v_exp_f32 v151, v151
    v_add_f32 v2, v2, v150
    s_nop 0
    v_add_f32 v2, v2, v151
    s_waitcnt lgkmcnt(6)
    v_mfma_f32_32x32x16_bf16 v[56:71], v[164:167], v[136:139], v[56:71]
    ds_read_b64_tr_b16 v[164:165], v1 offset:39360
    ds_read_b64_tr_b16 v[166:167], v1 offset:39872
    v_cvt_pk_bf16_f32 v147, v150, v151
    s_nop 1
    s_setprio 0
    s_waitcnt lgkmcnt(6)
    v_mfma_f32_32x32x16_bf16 v[8:23], v[152:155], v[144:147], v[8:23]
    ds_read_b128 v[152:155], v0 offset:50688
    v_max3_f32 v3, v120, v121, v122
    v_max3_f32 v3, v3, v123, v124
    v_max3_f32 v3, v3, v125, v126
    s_waitcnt lgkmcnt(5)
    v_mfma_f32_32x32x16_bf16 v[24:39], v[156:159], v[144:147], v[24:39]
    ds_read_b128 v[156:159], v0 offset:50720
    v_max3_f32 v3, v3, v127, v128
    v_max3_f32 v3, v3, v129, v130
    v_max3_f32 v3, v3, v131, v132
    s_waitcnt lgkmcnt(4)
    v_mfma_f32_32x32x16_bf16 v[40:55], v[160:163], v[144:147], v[40:55]
    ds_read_b128 v[160:163], v0 offset:50752
    v_max3_f32 v3, v3, v133, v134
    v_max_f32 v3, v3, v135
    v_cmp_lt_f32 vcc, s34, v3
    s_waitcnt lgkmcnt(3)
    v_mfma_f32_32x32x16_bf16 v[56:71], v[164:167], v[144:147], v[56:71]
    ds_read_b128 v[164:167], v0 offset:50784
    s_cbranch_vccz nr_49
    s_call_b64 s[32:33], standalone__mha_block_cached__near_ridge_kernel_rescale0
nr_49:
    s_waitcnt vmcnt(12)
    s_barrier
    s_setprio 3
    s_waitcnt lgkmcnt(3)
    v_mfma_f32_32x32x16_bf16 v[136:151], v[152:155], v[72:75], v[104:119]
    ds_read_b128 v[152:155], v0 offset:50816
    s_cmp_ge_u32 s28, 4
    s_cbranch_scc1 ld_50
    s_add_u32 m0, s38, 33792
    s_mov_b32 s36, 81920
    buffer_load_dwordx4 v5, s[16:19], s36 offen nt lds
    s_add_u32 m0, s38, 33824
    s_nop 0
    buffer_load_dwordx4 v5, s[16:19], s36 offen offset:1024 nt lds
ld_50:
    v_exp_f32 v120, v120
    v_exp_f32 v121, v121
    v_add_f32 v2, v2, v120
    v_exp_f32 v122, v122
    s_waitcnt lgkmcnt(3)
    v_mfma_f32_32x32x16_bf16 v[136:151], v[156:159], v[76:79], v[136:151]
    ds_read_b128 v[156:159], v0 offset:50848
    v_add_f32 v2, v2, v121
    v_cvt_pk_bf16_f32 v120, v120, v121
    v_exp_f32 v123, v123
    s_waitcnt lgkmcnt(3)
    v_mfma_f32_32x32x16_bf16 v[136:151], v[160:163], v[80:83], v[136:151]
    ds_read_b128 v[160:163], v0 offset:50880
    v_add_f32 v2, v2, v122
    v_exp_f32 v124, v124
    v_add_f32 v2, v2, v123
    v_cvt_pk_bf16_f32 v121, v122, v123
    s_waitcnt lgkmcnt(3)
    v_mfma_f32_32x32x16_bf16 v[136:151], v[164:167], v[84:87], v[136:151]
    ds_read_b128 v[164:167], v0 offset:50912
    s_cmp_ge_u32 s28, 4
    s_cbranch_scc1 ld_51
    s_add_u32 m0, s38, 42240
    s_mov_b32 s36, 212992
    buffer_load_dwordx4 v5, s[16:19], s36 offen nt lds
    s_add_u32 m0, s38, 42272
    s_nop 0
    buffer_load_dwordx4 v5, s[16:19], s36 offen offset:1024 nt lds
ld_51:
    v_exp_f32 v125, v125
    v_add_f32 v2, v2, v124
    v_exp_f32 v126, v126
    s_setprio 2
    s_waitcnt lgkmcnt(3)
    v_mfma_f32_32x32x16_bf16 v[136:151], v[152:155], v[88:91], v[136:151]
    ds_read_b64_tr_b16 v[152:153], v1 offset:17408
    ds_read_b64_tr_b16 v[154:155], v1 offset:17920
    v_add_f32 v2, v2, v125
    v_cvt_pk_bf16_f32 v122, v124, v125
    v_exp_f32 v127, v127
    v_add_f32 v2, v2, v126
    s_waitcnt lgkmcnt(4)
    v_mfma_f32_32x32x16_bf16 v[136:151], v[156:159], v[92:95], v[136:151]
    ds_read_b64_tr_b16 v[156:157], v1 offset:17472
    ds_read_b64_tr_b16 v[158:159], v1 offset:17984
    v_exp_f32 v128, v128
    v_add_f32 v2, v2, v127
    v_cvt_pk_bf16_f32 v123, v126, v127
    v_exp_f32 v129, v129
    s_waitcnt lgkmcnt(5)
    v_mfma_f32_32x32x16_bf16 v[136:151], v[160:163], v[96:99], v[136:151]
    ds_read_b64_tr_b16 v[160:161], v1 offset:17536
    ds_read_b64_tr_b16 v[162:163], v1 offset:18048
    s_cmp_ge_u32 s28, 4
    s_cbranch_scc1 ld_52
    s_add_u32 m0, s39, 129024
    s_mov_b32 s36, 73728
    buffer_load_dwordx4 v6, s[20:23], s36 offen nt lds
    s_add_u32 m0, s39, 129088
    s_nop 0
    buffer_load_dwordx4 v6, s[20:23], s36 offen offset:1024 nt lds
ld_52:
    v_add_f32 v2, v2, v128
    v_exp_f32 v130, v130
    v_add_f32 v2, v2, v129
    s_waitcnt lgkmcnt(6)
    v_mfma_f32_32x32x16_bf16 v[136:151], v[164:167], v[100:103], v[136:151]
    ds_read_b64_tr_b16 v[164:165], v1 offset:17600
    ds_read_b64_tr_b16 v[166:167], v1 offset:18112
    v_cvt_pk_bf16_f32 v128, v128, v129
    v_exp_f32 v131, v131
    v_add_f32 v2, v2, v130
    v_exp_f32 v132, v132
    s_setprio 1
    s_waitcnt lgkmcnt(6)
    v_mfma_f32_32x32x16_bf16 v[8:23], v[152:155], v[120:123], v[8:23]
    ds_read_b64_tr_b16 v[152:153], v1 offset:21760
    ds_read_b64_tr_b16 v[154:155], v1 offset:22272
    v_add_f32 v2, v2, v131
    v_cvt_pk_bf16_f32 v129, v130, v131
    v_exp_f32 v133, v133
    s_waitcnt lgkmcnt(6)
    v_mfma_f32_32x32x16_bf16 v[24:39], v[156:159], v[120:123], v[24:39]
    ds_read_b64_tr_b16 v[156:157], v1 offset:21824
    ds_read_b64_tr_b16 v[158:159], v1 offset:22336
    s_cmp_ge_u32 s28, 4
    s_cbranch_scc1 ld_53
    s_add_u32 m0, s39, 137728
    s_mov_b32 s36, 204800
    buffer_load_dwordx4 v6, s[20:23], s36 offen nt lds
    s_add_u32 m0, s39, 137792
    s_nop 0
    buffer_load_dwordx4 v6, s[20:23], s36 offen offset:1024 nt lds
ld_53:
    v_add_f32 v2, v2, v132
    v_exp_f32 v134, v134
    v_add_f32 v2, v2, v133
    v_cvt_pk_bf16_f32 v130, v132, v133
    s_waitcnt lgkmcnt(6)
    v_mfma_f32_32x32x16_bf16 v[40:55], v[160:163], v[120:123], v[40:55]
    ds_read_b64_tr_b16 v[160:161], v1 offset:21888
    ds_read_b64_tr_b16 v[162:163], v1 offset:22400
    v_exp_f32 v135, v135
    v_add_f32 v2, v2, v134
    s_nop 0
    v_add_f32 v2, v2, v135
    s_waitcnt lgkmcnt(6)
    v_mfma_f32_32x32x16_bf16 v[56:71], v[164:167], v[120:123], v[56:71]
    ds_read_b64_tr_b16 v[164:165], v1 offset:21952
    ds_read_b64_tr_b16 v[166:167], v1 offset:22464
    v_cvt_pk_bf16_f32 v131, v134, v135
    s_nop 1
    s_setprio 0
    s_waitcnt lgkmcnt(6)
    v_mfma_f32_32x32x16_bf16 v[8:23], v[152:155], v[128:131], v[8:23]
    ds_read_b128 v[152:155], v0 offset:0
    v_max3_f32 v3, v136, v137, v138
    v_max3_f32 v3, v3, v139, v140
    v_max3_f32 v3, v3, v141, v142
    s_waitcnt lgkmcnt(5)
    v_mfma_f32_32x32x16_bf16 v[24:39], v[156:159], v[128:131], v[24:39]
    ds_read_b128 v[156:159], v0 offset:32
    v_max3_f32 v3, v3, v143, v144
    v_max3_f32 v3, v3, v145, v146
    v_max3_f32 v3, v3, v147, v148
    s_waitcnt lgkmcnt(4)
    v_mfma_f32_32x32x16_bf16 v[40:55], v[160:163], v[128:131], v[40:55]
    ds_read_b128 v[160:163], v0 offset:64
    v_max3_f32 v3, v3, v149, v150
    v_max_f32 v3, v3, v151
    v_cmp_lt_f32 vcc, s34, v3
    s_waitcnt lgkmcnt(3)
    v_mfma_f32_32x32x16_bf16 v[56:71], v[164:167], v[128:131], v[56:71]
    ds_read_b128 v[164:167], v0 offset:96
    s_cbranch_vccz nr_54
    s_call_b64 s[32:33], standalone__mha_block_cached__near_ridge_kernel_rescale1
nr_54:
    s_waitcnt vmcnt(12)
    s_barrier
    s_setprio 3
    s_waitcnt lgkmcnt(3)
    v_mfma_f32_32x32x16_bf16 v[120:135], v[152:155], v[72:75], v[104:119]
    ds_read_b128 v[152:155], v0 offset:128
    s_cmp_ge_u32 s28, 4
    s_cbranch_scc1 ld_55
    s_add_u32 m0, s38, 50688
    s_mov_b32 s36, 90112
    buffer_load_dwordx4 v5, s[16:19], s36 offen nt lds
    s_add_u32 m0, s38, 50720
    s_nop 0
    buffer_load_dwordx4 v5, s[16:19], s36 offen offset:1024 nt lds
ld_55:
    v_exp_f32 v136, v136
    v_exp_f32 v137, v137
    v_add_f32 v2, v2, v136
    v_exp_f32 v138, v138
    s_waitcnt lgkmcnt(3)
    v_mfma_f32_32x32x16_bf16 v[120:135], v[156:159], v[76:79], v[120:135]
    ds_read_b128 v[156:159], v0 offset:160
    v_add_f32 v2, v2, v137
    v_cvt_pk_bf16_f32 v136, v136, v137
    v_exp_f32 v139, v139
    s_waitcnt lgkmcnt(3)
    v_mfma_f32_32x32x16_bf16 v[120:135], v[160:163], v[80:83], v[120:135]
    ds_read_b128 v[160:163], v0 offset:192
    v_add_f32 v2, v2, v138
    v_exp_f32 v140, v140
    v_add_f32 v2, v2, v139
    v_cvt_pk_bf16_f32 v137, v138, v139
    s_waitcnt lgkmcnt(3)
    v_mfma_f32_32x32x16_bf16 v[120:135], v[164:167], v[84:87], v[120:135]
    ds_read_b128 v[164:167], v0 offset:224
    s_cmp_ge_u32 s28, 4
    s_cbranch_scc1 ld_56
    s_add_u32 m0, s38, 59136
    s_mov_b32 s36, 221184
    buffer_load_dwordx4 v5, s[16:19], s36 offen nt lds
    s_add_u32 m0, s38, 59168
    s_nop 0
    buffer_load_dwordx4 v5, s[16:19], s36 offen offset:1024 nt lds
ld_56:
    v_exp_f32 v141, v141
    v_add_f32 v2, v2, v140
    v_exp_f32 v142, v142
    s_setprio 2
    s_waitcnt lgkmcnt(3)
    v_mfma_f32_32x32x16_bf16 v[120:135], v[152:155], v[88:91], v[120:135]
    ds_read_b64_tr_b16 v[152:153], v1 offset:0
    ds_read_b64_tr_b16 v[154:155], v1 offset:512
    v_add_f32 v2, v2, v141
    v_cvt_pk_bf16_f32 v138, v140, v141
    v_exp_f32 v143, v143
    v_add_f32 v2, v2, v142
    s_waitcnt lgkmcnt(4)
    v_mfma_f32_32x32x16_bf16 v[120:135], v[156:159], v[92:95], v[120:135]
    ds_read_b64_tr_b16 v[156:157], v1 offset:64
    ds_read_b64_tr_b16 v[158:159], v1 offset:576
    v_exp_f32 v144, v144
    v_add_f32 v2, v2, v143
    v_cvt_pk_bf16_f32 v139, v142, v143
    v_exp_f32 v145, v145
    s_waitcnt lgkmcnt(5)
    v_mfma_f32_32x32x16_bf16 v[120:135], v[160:163], v[96:99], v[120:135]
    ds_read_b64_tr_b16 v[160:161], v1 offset:128
    ds_read_b64_tr_b16 v[162:163], v1 offset:640
    s_cmp_ge_u32 s28, 4
    s_cbranch_scc1 ld_57
    s_add_u32 m0, s39, 111616
    s_mov_b32 s36, 81920
    buffer_load_dwordx4 v6, s[20:23], s36 offen nt lds
    s_add_u32 m0, s39, 111680
    s_nop 0
    buffer_load_dwordx4 v6, s[20:23], s36 offen offset:1024 nt lds
ld_57:
    v_add_f32 v2, v2, v144
    v_exp_f32 v146, v146
    v_add_f32 v2, v2, v145
    s_waitcnt lgkmcnt(6)
    v_mfma_f32_32x32x16_bf16 v[120:135], v[164:167], v[100:103], v[120:135]
    ds_read_b64_tr_b16 v[164:165], v1 offset:192
    ds_read_b64_tr_b16 v[166:167], v1 offset:704
    v_cvt_pk_bf16_f32 v144, v144, v145
    v_exp_f32 v147, v147
    v_add_f32 v2, v2, v146
    v_exp_f32 v148, v148
    s_setprio 1
    s_waitcnt lgkmcnt(6)
    v_mfma_f32_32x32x16_bf16 v[8:23], v[152:155], v[136:139], v[8:23]
    ds_read_b64_tr_b16 v[152:153], v1 offset:4352
    ds_read_b64_tr_b16 v[154:155], v1 offset:4864
    v_add_f32 v2, v2, v147
    v_cvt_pk_bf16_f32 v145, v146, v147
    v_exp_f32 v149, v149
    s_waitcnt lgkmcnt(6)
    v_mfma_f32_32x32x16_bf16 v[24:39], v[156:159], v[136:139], v[24:39]
    ds_read_b64_tr_b16 v[156:157], v1 offset:4416
    ds_read_b64_tr_b16 v[158:159], v1 offset:4928
    s_cmp_ge_u32 s28, 4
    s_cbranch_scc1 ld_58
    s_add_u32 m0, s39, 120320
    s_mov_b32 s36, 212992
    buffer_load_dwordx4 v6, s[20:23], s36 offen nt lds
    s_add_u32 m0, s39, 120384
    s_nop 0
    buffer_load_dwordx4 v6, s[20:23], s36 offen offset:1024 nt lds
ld_58:
    v_add_f32 v2, v2, v148
    v_exp_f32 v150, v150
    v_add_f32 v2, v2, v149
    v_cvt_pk_bf16_f32 v146, v148, v149
    s_waitcnt lgkmcnt(6)
    v_mfma_f32_32x32x16_bf16 v[40:55], v[160:163], v[136:139], v[40:55]
    ds_read_b64_tr_b16 v[160:161], v1 offset:4480
    ds_read_b64_tr_b16 v[162:163], v1 offset:4992
    v_exp_f32 v151, v151
    v_add_f32 v2, v2, v150
    s_nop 0
    v_add_f32 v2, v2, v151
    s_waitcnt lgkmcnt(6)
    v_mfma_f32_32x32x16_bf16 v[56:71], v[164:167], v[136:139], v[56:71]
    ds_read_b64_tr_b16 v[164:165], v1 offset:4544
    ds_read_b64_tr_b16 v[166:167], v1 offset:5056
    v_cvt_pk_bf16_f32 v147, v150, v151
    s_nop 1
    s_setprio 0
    s_waitcnt lgkmcnt(6)
    v_mfma_f32_32x32x16_bf16 v[8:23], v[152:155], v[144:147], v[8:23]
    ds_read_b128 v[152:155], v0 offset:16896
    v_max3_f32 v3, v120, v121, v122
    v_max3_f32 v3, v3, v123, v124
    v_max3_f32 v3, v3, v125, v126
    s_waitcnt lgkmcnt(5)
    v_mfma_f32_32x32x16_bf16 v[24:39], v[156:159], v[144:147], v[24:39]
    ds_read_b128 v[156:159], v0 offset:16928
    v_max3_f32 v3, v3, v127, v128
    v_max3_f32 v3, v3, v129, v130
    v_max3_f32 v3, v3, v131, v132
    s_waitcnt lgkmcnt(4)
    v_mfma_f32_32x32x16_bf16 v[40:55], v[160:163], v[144:147], v[40:55]
    ds_read_b128 v[160:163], v0 offset:16960
    v_max3_f32 v3, v3, v133, v134
    v_max_f32 v3, v3, v135
    v_cmp_lt_f32 vcc, s34, v3
    s_waitcnt lgkmcnt(3)
    v_mfma_f32_32x32x16_bf16 v[56:71], v[164:167], v[144:147], v[56:71]
    ds_read_b128 v[164:167], v0 offset:16992
    s_cbranch_vccz nr_59
    s_call_b64 s[32:33], standalone__mha_block_cached__near_ridge_kernel_rescale0
nr_59:
    s_waitcnt vmcnt(12)
    s_barrier
    s_setprio 3
    s_waitcnt lgkmcnt(3)
    v_mfma_f32_32x32x16_bf16 v[136:151], v[152:155], v[72:75], v[104:119]
    ds_read_b128 v[152:155], v0 offset:17024
    s_cmp_ge_u32 s28, 4
    s_cbranch_scc1 ld_60
    s_add_u32 m0, s38, 0
    s_mov_b32 s36, 98304
    buffer_load_dwordx4 v5, s[16:19], s36 offen nt lds
    s_add_u32 m0, s38, 32
    s_nop 0
    buffer_load_dwordx4 v5, s[16:19], s36 offen offset:1024 nt lds
ld_60:
    v_exp_f32 v120, v120
    v_exp_f32 v121, v121
    v_add_f32 v2, v2, v120
    v_exp_f32 v122, v122
    s_waitcnt lgkmcnt(3)
    v_mfma_f32_32x32x16_bf16 v[136:151], v[156:159], v[76:79], v[136:151]
    ds_read_b128 v[156:159], v0 offset:17056
    v_add_f32 v2, v2, v121
    v_cvt_pk_bf16_f32 v120, v120, v121
    v_exp_f32 v123, v123
    s_waitcnt lgkmcnt(3)
    v_mfma_f32_32x32x16_bf16 v[136:151], v[160:163], v[80:83], v[136:151]
    ds_read_b128 v[160:163], v0 offset:17088
    v_add_f32 v2, v2, v122
    v_exp_f32 v124, v124
    v_add_f32 v2, v2, v123
    v_cvt_pk_bf16_f32 v121, v122, v123
    s_waitcnt lgkmcnt(3)
    v_mfma_f32_32x32x16_bf16 v[136:151], v[164:167], v[84:87], v[136:151]
    ds_read_b128 v[164:167], v0 offset:17120
    s_cmp_ge_u32 s28, 4
    s_cbranch_scc1 ld_61
    s_add_u32 m0, s38, 8448
    s_mov_b32 s36, 229376
    buffer_load_dwordx4 v5, s[16:19], s36 offen nt lds
    s_add_u32 m0, s38, 8480
    s_nop 0
    buffer_load_dwordx4 v5, s[16:19], s36 offen offset:1024 nt lds
ld_61:
    v_exp_f32 v125, v125
    v_add_f32 v2, v2, v124
    v_exp_f32 v126, v126
    s_setprio 2
    s_waitcnt lgkmcnt(3)
    v_mfma_f32_32x32x16_bf16 v[136:151], v[152:155], v[88:91], v[136:151]
    ds_read_b64_tr_b16 v[152:153], v1 offset:52224
    ds_read_b64_tr_b16 v[154:155], v1 offset:52736
    v_add_f32 v2, v2, v125
    v_cvt_pk_bf16_f32 v122, v124, v125
    v_exp_f32 v127, v127
    v_add_f32 v2, v2, v126
    s_waitcnt lgkmcnt(4)
    v_mfma_f32_32x32x16_bf16 v[136:151], v[156:159], v[92:95], v[136:151]
    ds_read_b64_tr_b16 v[156:157], v1 offset:52288
    ds_read_b64_tr_b16 v[158:159], v1 offset:52800
    v_exp_f32 v128, v128
    v_add_f32 v2, v2, v127
    v_cvt_pk_bf16_f32 v123, v126, v127
    v_exp_f32 v129, v129
    s_waitcnt lgkmcnt(5)
    v_mfma_f32_32x32x16_bf16 v[136:151], v[160:163], v[96:99], v[136:151]
    ds_read_b64_tr_b16 v[160:161], v1 offset:52352
    ds_read_b64_tr_b16 v[162:163], v1 offset:52864
    s_cmp_ge_u32 s28, 4
    s_cbranch_scc1 ld_62
    s_add_u32 m0, s39, 94208
    s_mov_b32 s36, 90112
    buffer_load_dwordx4 v6, s[20:23], s36 offen nt lds
    s_add_u32 m0, s39, 94272
    s_nop 0
    buffer_load_dwordx4 v6, s[20:23], s36 offen offset:1024 nt lds
ld_62:
    v_add_f32 v2, v2, v128
    v_exp_f32 v130, v130
    v_add_f32 v2, v2, v129
    s_waitcnt lgkmcnt(6)
    v_mfma_f32_32x32x16_bf16 v[136:151], v[164:167], v[100:103], v[136:151]
    ds_read_b64_tr_b16 v[164:165], v1 offset:52416
    ds_read_b64_tr_b16 v[166:167], v1 offset:52928
    v_cvt_pk_bf16_f32 v128, v128, v129
    v_exp_f32 v131, v131
    v_add_f32 v2, v2, v130
    v_exp_f32 v132, v132
    s_setprio 1
    s_waitcnt lgkmcnt(6)
    v_mfma_f32_32x32x16_bf16 v[8:23], v[152:155], v[120:123], v[8:23]
    ds_read_b64_tr_b16 v[152:153], v1 offset:56576
    ds_read_b64_tr_b16 v[154:155], v1 offset:57088
    v_add_f32 v2, v2, v131
    v_cvt_pk_bf16_f32 v129, v130, v131
    v_exp_f32 v133, v133
    s_waitcnt lgkmcnt(6)
    v_mfma_f32_32x32x16_bf16 v[24:39], v[156:159], v[120:123], v[24:39]
    ds_read_b64_tr_b16 v[156:157], v1 offset:56640
    ds_read_b64_tr_b16 v[158:159], v1 offset:57152
    s_cmp_ge_u32 s28, 4
    s_cbranch_scc1 ld_63
    s_add_u32 m0, s39, 102912
    s_mov_b32 s36, 221184
    buffer_load_dwordx4 v6, s[20:23], s36 offen nt lds
    s_add_u32 m0, s39, 102976
    s_nop 0
    buffer_load_dwordx4 v6, s[20:23], s36 offen offset:1024 nt lds
ld_63:
    v_add_f32 v2, v2, v132
    v_exp_f32 v134, v134
    v_add_f32 v2, v2, v133
    v_cvt_pk_bf16_f32 v130, v132, v133
    s_waitcnt lgkmcnt(6)
    v_mfma_f32_32x32x16_bf16 v[40:55], v[160:163], v[120:123], v[40:55]
    ds_read_b64_tr_b16 v[160:161], v1 offset:56704
    ds_read_b64_tr_b16 v[162:163], v1 offset:57216
    v_exp_f32 v135, v135
    v_add_f32 v2, v2, v134
    s_nop 0
    v_add_f32 v2, v2, v135
    s_waitcnt lgkmcnt(6)
    v_mfma_f32_32x32x16_bf16 v[56:71], v[164:167], v[120:123], v[56:71]
    ds_read_b64_tr_b16 v[164:165], v1 offset:56768
    ds_read_b64_tr_b16 v[166:167], v1 offset:57280
    v_cvt_pk_bf16_f32 v131, v134, v135
    s_nop 1
    s_setprio 0
    s_waitcnt lgkmcnt(6)
    v_mfma_f32_32x32x16_bf16 v[8:23], v[152:155], v[128:131], v[8:23]
    ds_read_b128 v[152:155], v0 offset:33792
    v_max3_f32 v3, v136, v137, v138
    v_max3_f32 v3, v3, v139, v140
    v_max3_f32 v3, v3, v141, v142
    s_waitcnt lgkmcnt(5)
    v_mfma_f32_32x32x16_bf16 v[24:39], v[156:159], v[128:131], v[24:39]
    ds_read_b128 v[156:159], v0 offset:33824
    v_max3_f32 v3, v3, v143, v144
    v_max3_f32 v3, v3, v145, v146
    v_max3_f32 v3, v3, v147, v148
    s_waitcnt lgkmcnt(4)
    v_mfma_f32_32x32x16_bf16 v[40:55], v[160:163], v[128:131], v[40:55]
    ds_read_b128 v[160:163], v0 offset:33856
    v_max3_f32 v3, v3, v149, v150
    v_max_f32 v3, v3, v151
    v_cmp_lt_f32 vcc, s34, v3
    s_waitcnt lgkmcnt(3)
    v_mfma_f32_32x32x16_bf16 v[56:71], v[164:167], v[128:131], v[56:71]
    ds_read_b128 v[164:167], v0 offset:33888
    s_cbranch_vccz nr_64
    s_call_b64 s[32:33], standalone__mha_block_cached__near_ridge_kernel_rescale1
nr_64:
    s_waitcnt vmcnt(12)
    s_barrier
    s_setprio 3
    s_waitcnt lgkmcnt(3)
    v_mfma_f32_32x32x16_bf16 v[120:135], v[152:155], v[72:75], v[104:119]
    ds_read_b128 v[152:155], v0 offset:33920
    s_cmp_ge_u32 s28, 4
    s_cbranch_scc1 ld_65
    s_add_u32 m0, s38, 16896
    s_mov_b32 s36, 106496
    buffer_load_dwordx4 v5, s[16:19], s36 offen nt lds
    s_add_u32 m0, s38, 16928
    s_nop 0
    buffer_load_dwordx4 v5, s[16:19], s36 offen offset:1024 nt lds
ld_65:
    v_exp_f32 v136, v136
    v_exp_f32 v137, v137
    v_add_f32 v2, v2, v136
    v_exp_f32 v138, v138
    s_waitcnt lgkmcnt(3)
    v_mfma_f32_32x32x16_bf16 v[120:135], v[156:159], v[76:79], v[120:135]
    ds_read_b128 v[156:159], v0 offset:33952
    v_add_f32 v2, v2, v137
    v_cvt_pk_bf16_f32 v136, v136, v137
    v_exp_f32 v139, v139
    s_waitcnt lgkmcnt(3)
    v_mfma_f32_32x32x16_bf16 v[120:135], v[160:163], v[80:83], v[120:135]
    ds_read_b128 v[160:163], v0 offset:33984
    v_add_f32 v2, v2, v138
    v_exp_f32 v140, v140
    v_add_f32 v2, v2, v139
    v_cvt_pk_bf16_f32 v137, v138, v139
    s_waitcnt lgkmcnt(3)
    v_mfma_f32_32x32x16_bf16 v[120:135], v[164:167], v[84:87], v[120:135]
    ds_read_b128 v[164:167], v0 offset:34016
    s_cmp_ge_u32 s28, 4
    s_cbranch_scc1 ld_66
    s_add_u32 m0, s38, 25344
    s_mov_b32 s36, 237568
    buffer_load_dwordx4 v5, s[16:19], s36 offen nt lds
    s_add_u32 m0, s38, 25376
    s_nop 0
    buffer_load_dwordx4 v5, s[16:19], s36 offen offset:1024 nt lds
ld_66:
    v_exp_f32 v141, v141
    v_add_f32 v2, v2, v140
    v_exp_f32 v142, v142
    s_setprio 2
    s_waitcnt lgkmcnt(3)
    v_mfma_f32_32x32x16_bf16 v[120:135], v[152:155], v[88:91], v[120:135]
    ds_read_b64_tr_b16 v[152:153], v1 offset:34816
    ds_read_b64_tr_b16 v[154:155], v1 offset:35328
    v_add_f32 v2, v2, v141
    v_cvt_pk_bf16_f32 v138, v140, v141
    v_exp_f32 v143, v143
    v_add_f32 v2, v2, v142
    s_waitcnt lgkmcnt(4)
    v_mfma_f32_32x32x16_bf16 v[120:135], v[156:159], v[92:95], v[120:135]
    ds_read_b64_tr_b16 v[156:157], v1 offset:34880
    ds_read_b64_tr_b16 v[158:159], v1 offset:35392
    v_exp_f32 v144, v144
    v_add_f32 v2, v2, v143
    v_cvt_pk_bf16_f32 v139, v142, v143
    v_exp_f32 v145, v145
    s_waitcnt lgkmcnt(5)
    v_mfma_f32_32x32x16_bf16 v[120:135], v[160:163], v[96:99], v[120:135]
    ds_read_b64_tr_b16 v[160:161], v1 offset:34944
    ds_read_b64_tr_b16 v[162:163], v1 offset:35456
    s_cmp_ge_u32 s28, 4
    s_cbranch_scc1 ld_67
    s_add_u32 m0, s39, 146432
    s_mov_b32 s36, 98304
    buffer_load_dwordx4 v6, s[20:23], s36 offen nt lds
    s_add_u32 m0, s39, 146496
    s_nop 0
    buffer_load_dwordx4 v6, s[20:23], s36 offen offset:1024 nt lds
ld_67:
    v_add_f32 v2, v2, v144
    v_exp_f32 v146, v146
    v_add_f32 v2, v2, v145
    s_waitcnt lgkmcnt(6)
    v_mfma_f32_32x32x16_bf16 v[120:135], v[164:167], v[100:103], v[120:135]
    ds_read_b64_tr_b16 v[164:165], v1 offset:35008
    ds_read_b64_tr_b16 v[166:167], v1 offset:35520
    v_cvt_pk_bf16_f32 v144, v144, v145
    v_exp_f32 v147, v147
    v_add_f32 v2, v2, v146
    v_exp_f32 v148, v148
    s_setprio 1
    s_waitcnt lgkmcnt(6)
    v_mfma_f32_32x32x16_bf16 v[8:23], v[152:155], v[136:139], v[8:23]
    ds_read_b64_tr_b16 v[152:153], v1 offset:39168
    ds_read_b64_tr_b16 v[154:155], v1 offset:39680
    v_add_f32 v2, v2, v147
    v_cvt_pk_bf16_f32 v145, v146, v147
    v_exp_f32 v149, v149
    s_waitcnt lgkmcnt(6)
    v_mfma_f32_32x32x16_bf16 v[24:39], v[156:159], v[136:139], v[24:39]
    ds_read_b64_tr_b16 v[156:157], v1 offset:39232
    ds_read_b64_tr_b16 v[158:159], v1 offset:39744
    s_cmp_ge_u32 s28, 4
    s_cbranch_scc1 ld_68
    s_add_u32 m0, s39, 155136
    s_mov_b32 s36, 229376
    buffer_load_dwordx4 v6, s[20:23], s36 offen nt lds
    s_add_u32 m0, s39, 155200
    s_nop 0
    buffer_load_dwordx4 v6, s[20:23], s36 offen offset:1024 nt lds
ld_68:
    v_add_f32 v2, v2, v148
    v_exp_f32 v150, v150
    v_add_f32 v2, v2, v149
    v_cvt_pk_bf16_f32 v146, v148, v149
    s_waitcnt lgkmcnt(6)
    v_mfma_f32_32x32x16_bf16 v[40:55], v[160:163], v[136:139], v[40:55]
    ds_read_b64_tr_b16 v[160:161], v1 offset:39296
    ds_read_b64_tr_b16 v[162:163], v1 offset:39808
    v_exp_f32 v151, v151
    v_add_f32 v2, v2, v150
    s_nop 0
    v_add_f32 v2, v2, v151
    s_waitcnt lgkmcnt(6)
    v_mfma_f32_32x32x16_bf16 v[56:71], v[164:167], v[136:139], v[56:71]
    ds_read_b64_tr_b16 v[164:165], v1 offset:39360
    ds_read_b64_tr_b16 v[166:167], v1 offset:39872
    v_cvt_pk_bf16_f32 v147, v150, v151
    s_nop 1
    s_setprio 0
    s_waitcnt lgkmcnt(6)
    v_mfma_f32_32x32x16_bf16 v[8:23], v[152:155], v[144:147], v[8:23]
    ds_read_b128 v[152:155], v0 offset:50688
    v_max3_f32 v3, v120, v121, v122
    v_max3_f32 v3, v3, v123, v124
    v_max3_f32 v3, v3, v125, v126
    s_waitcnt lgkmcnt(5)
    v_mfma_f32_32x32x16_bf16 v[24:39], v[156:159], v[144:147], v[24:39]
    ds_read_b128 v[156:159], v0 offset:50720
    v_max3_f32 v3, v3, v127, v128
    v_max3_f32 v3, v3, v129, v130
    v_max3_f32 v3, v3, v131, v132
    s_waitcnt lgkmcnt(4)
    v_mfma_f32_32x32x16_bf16 v[40:55], v[160:163], v[144:147], v[40:55]
    ds_read_b128 v[160:163], v0 offset:50752
    v_max3_f32 v3, v3, v133, v134
    v_max_f32 v3, v3, v135
    v_cmp_lt_f32 vcc, s34, v3
    s_waitcnt lgkmcnt(3)
    v_mfma_f32_32x32x16_bf16 v[56:71], v[164:167], v[144:147], v[56:71]
    ds_read_b128 v[164:167], v0 offset:50784
    s_cbranch_vccz nr_69
    s_call_b64 s[32:33], standalone__mha_block_cached__near_ridge_kernel_rescale0
nr_69:
    s_waitcnt vmcnt(12)
    s_barrier
    s_setprio 3
    s_waitcnt lgkmcnt(3)
    v_mfma_f32_32x32x16_bf16 v[136:151], v[152:155], v[72:75], v[104:119]
    ds_read_b128 v[152:155], v0 offset:50816
    s_cmp_ge_u32 s28, 4
    s_cbranch_scc1 ld_70
    s_add_u32 m0, s38, 33792
    s_mov_b32 s36, 114688
    buffer_load_dwordx4 v5, s[16:19], s36 offen nt lds
    s_add_u32 m0, s38, 33824
    s_nop 0
    buffer_load_dwordx4 v5, s[16:19], s36 offen offset:1024 nt lds
ld_70:
    v_exp_f32 v120, v120
    v_exp_f32 v121, v121
    v_add_f32 v2, v2, v120
    v_exp_f32 v122, v122
    s_waitcnt lgkmcnt(3)
    v_mfma_f32_32x32x16_bf16 v[136:151], v[156:159], v[76:79], v[136:151]
    ds_read_b128 v[156:159], v0 offset:50848
    v_add_f32 v2, v2, v121
    v_cvt_pk_bf16_f32 v120, v120, v121
    v_exp_f32 v123, v123
    s_waitcnt lgkmcnt(3)
    v_mfma_f32_32x32x16_bf16 v[136:151], v[160:163], v[80:83], v[136:151]
    ds_read_b128 v[160:163], v0 offset:50880
    v_add_f32 v2, v2, v122
    v_exp_f32 v124, v124
    v_add_f32 v2, v2, v123
    v_cvt_pk_bf16_f32 v121, v122, v123
    s_waitcnt lgkmcnt(3)
    v_mfma_f32_32x32x16_bf16 v[136:151], v[164:167], v[84:87], v[136:151]
    ds_read_b128 v[164:167], v0 offset:50912
    s_cmp_ge_u32 s28, 4
    s_cbranch_scc1 ld_71
    s_add_u32 m0, s38, 42240
    s_mov_b32 s36, 245760
    buffer_load_dwordx4 v5, s[16:19], s36 offen nt lds
    s_add_u32 m0, s38, 42272
    s_nop 0
    buffer_load_dwordx4 v5, s[16:19], s36 offen offset:1024 nt lds
ld_71:
    v_exp_f32 v125, v125
    v_add_f32 v2, v2, v124
    v_exp_f32 v126, v126
    s_setprio 2
    s_waitcnt lgkmcnt(3)
    v_mfma_f32_32x32x16_bf16 v[136:151], v[152:155], v[88:91], v[136:151]
    ds_read_b64_tr_b16 v[152:153], v1 offset:17408
    ds_read_b64_tr_b16 v[154:155], v1 offset:17920
    v_add_f32 v2, v2, v125
    v_cvt_pk_bf16_f32 v122, v124, v125
    v_exp_f32 v127, v127
    v_add_f32 v2, v2, v126
    s_waitcnt lgkmcnt(4)
    v_mfma_f32_32x32x16_bf16 v[136:151], v[156:159], v[92:95], v[136:151]
    ds_read_b64_tr_b16 v[156:157], v1 offset:17472
    ds_read_b64_tr_b16 v[158:159], v1 offset:17984
    v_exp_f32 v128, v128
    v_add_f32 v2, v2, v127
    v_cvt_pk_bf16_f32 v123, v126, v127
    v_exp_f32 v129, v129
    s_waitcnt lgkmcnt(5)
    v_mfma_f32_32x32x16_bf16 v[136:151], v[160:163], v[96:99], v[136:151]
    ds_read_b64_tr_b16 v[160:161], v1 offset:17536
    ds_read_b64_tr_b16 v[162:163], v1 offset:18048
    s_cmp_ge_u32 s28, 4
    s_cbranch_scc1 ld_72
    s_add_u32 m0, s39, 129024
    s_mov_b32 s36, 106496
    buffer_load_dwordx4 v6, s[20:23], s36 offen nt lds
    s_add_u32 m0, s39, 129088
    s_nop 0
    buffer_load_dwordx4 v6, s[20:23], s36 offen offset:1024 nt lds
ld_72:
    v_add_f32 v2, v2, v128
    v_exp_f32 v130, v130
    v_add_f32 v2, v2, v129
    s_waitcnt lgkmcnt(6)
    v_mfma_f32_32x32x16_bf16 v[136:151], v[164:167], v[100:103], v[136:151]
    ds_read_b64_tr_b16 v[164:165], v1 offset:17600
    ds_read_b64_tr_b16 v[166:167], v1 offset:18112
    v_cvt_pk_bf16_f32 v128, v128, v129
    v_exp_f32 v131, v131
    v_add_f32 v2, v2, v130
    v_exp_f32 v132, v132
    s_setprio 1
    s_waitcnt lgkmcnt(6)
    v_mfma_f32_32x32x16_bf16 v[8:23], v[152:155], v[120:123], v[8:23]
    ds_read_b64_tr_b16 v[152:153], v1 offset:21760
    ds_read_b64_tr_b16 v[154:155], v1 offset:22272
    v_add_f32 v2, v2, v131
    v_cvt_pk_bf16_f32 v129, v130, v131
    v_exp_f32 v133, v133
    s_waitcnt lgkmcnt(6)
    v_mfma_f32_32x32x16_bf16 v[24:39], v[156:159], v[120:123], v[24:39]
    ds_read_b64_tr_b16 v[156:157], v1 offset:21824
    ds_read_b64_tr_b16 v[158:159], v1 offset:22336
    s_cmp_ge_u32 s28, 4
    s_cbranch_scc1 ld_73
    s_add_u32 m0, s39, 137728
    s_mov_b32 s36, 237568
    buffer_load_dwordx4 v6, s[20:23], s36 offen nt lds
    s_add_u32 m0, s39, 137792
    s_nop 0
    buffer_load_dwordx4 v6, s[20:23], s36 offen offset:1024 nt lds
ld_73:
    v_add_f32 v2, v2, v132
    v_exp_f32 v134, v134
    v_add_f32 v2, v2, v133
    v_cvt_pk_bf16_f32 v130, v132, v133
    s_waitcnt lgkmcnt(6)
    v_mfma_f32_32x32x16_bf16 v[40:55], v[160:163], v[120:123], v[40:55]
    ds_read_b64_tr_b16 v[160:161], v1 offset:21888
    ds_read_b64_tr_b16 v[162:163], v1 offset:22400
    v_exp_f32 v135, v135
    v_add_f32 v2, v2, v134
    s_nop 0
    v_add_f32 v2, v2, v135
    s_waitcnt lgkmcnt(6)
    v_mfma_f32_32x32x16_bf16 v[56:71], v[164:167], v[120:123], v[56:71]
    ds_read_b64_tr_b16 v[164:165], v1 offset:21952
    ds_read_b64_tr_b16 v[166:167], v1 offset:22464
    v_cvt_pk_bf16_f32 v131, v134, v135
    s_nop 1
    s_setprio 0
    s_waitcnt lgkmcnt(6)
    v_mfma_f32_32x32x16_bf16 v[8:23], v[152:155], v[128:131], v[8:23]
    ds_read_b128 v[152:155], v0 offset:0
    v_max3_f32 v3, v136, v137, v138
    v_max3_f32 v3, v3, v139, v140
    v_max3_f32 v3, v3, v141, v142
    s_waitcnt lgkmcnt(5)
    v_mfma_f32_32x32x16_bf16 v[24:39], v[156:159], v[128:131], v[24:39]
    ds_read_b128 v[156:159], v0 offset:32
    v_max3_f32 v3, v3, v143, v144
    v_max3_f32 v3, v3, v145, v146
    v_max3_f32 v3, v3, v147, v148
    s_waitcnt lgkmcnt(4)
    v_mfma_f32_32x32x16_bf16 v[40:55], v[160:163], v[128:131], v[40:55]
    ds_read_b128 v[160:163], v0 offset:64
    v_max3_f32 v3, v3, v149, v150
    v_max_f32 v3, v3, v151
    v_cmp_lt_f32 vcc, s34, v3
    s_waitcnt lgkmcnt(3)
    v_mfma_f32_32x32x16_bf16 v[56:71], v[164:167], v[128:131], v[56:71]
    ds_read_b128 v[164:167], v0 offset:96
    s_cbranch_vccz nr_74
    s_call_b64 s[32:33], standalone__mha_block_cached__near_ridge_kernel_rescale1
nr_74:
    s_waitcnt vmcnt(12)
    s_barrier
    s_setprio 3
    s_waitcnt lgkmcnt(3)
    v_mfma_f32_32x32x16_bf16 v[120:135], v[152:155], v[72:75], v[104:119]
    ds_read_b128 v[152:155], v0 offset:128
    s_cmp_ge_u32 s28, 4
    s_cbranch_scc1 ld_75
    s_add_u32 m0, s38, 50688
    s_mov_b32 s36, 122880
    buffer_load_dwordx4 v5, s[16:19], s36 offen nt lds
    s_add_u32 m0, s38, 50720
    s_nop 0
    buffer_load_dwordx4 v5, s[16:19], s36 offen offset:1024 nt lds
ld_75:
    v_exp_f32 v136, v136
    v_exp_f32 v137, v137
    v_add_f32 v2, v2, v136
    v_exp_f32 v138, v138
    s_waitcnt lgkmcnt(3)
    v_mfma_f32_32x32x16_bf16 v[120:135], v[156:159], v[76:79], v[120:135]
    ds_read_b128 v[156:159], v0 offset:160
    v_add_f32 v2, v2, v137
    v_cvt_pk_bf16_f32 v136, v136, v137
    v_exp_f32 v139, v139
    s_waitcnt lgkmcnt(3)
    v_mfma_f32_32x32x16_bf16 v[120:135], v[160:163], v[80:83], v[120:135]
    ds_read_b128 v[160:163], v0 offset:192
    v_add_f32 v2, v2, v138
    v_exp_f32 v140, v140
    v_add_f32 v2, v2, v139
    v_cvt_pk_bf16_f32 v137, v138, v139
    s_waitcnt lgkmcnt(3)
    v_mfma_f32_32x32x16_bf16 v[120:135], v[164:167], v[84:87], v[120:135]
    ds_read_b128 v[164:167], v0 offset:224
    s_cmp_ge_u32 s28, 4
    s_cbranch_scc1 ld_76
    s_add_u32 m0, s38, 59136
    s_mov_b32 s36, 253952
    buffer_load_dwordx4 v5, s[16:19], s36 offen nt lds
    s_add_u32 m0, s38, 59168
    s_nop 0
    buffer_load_dwordx4 v5, s[16:19], s36 offen offset:1024 nt lds
ld_76:
    v_exp_f32 v141, v141
    v_add_f32 v2, v2, v140
    v_exp_f32 v142, v142
    s_setprio 2
    s_waitcnt lgkmcnt(3)
    v_mfma_f32_32x32x16_bf16 v[120:135], v[152:155], v[88:91], v[120:135]
    ds_read_b64_tr_b16 v[152:153], v1 offset:0
    ds_read_b64_tr_b16 v[154:155], v1 offset:512
    v_add_f32 v2, v2, v141
    v_cvt_pk_bf16_f32 v138, v140, v141
    v_exp_f32 v143, v143
    v_add_f32 v2, v2, v142
    s_waitcnt lgkmcnt(4)
    v_mfma_f32_32x32x16_bf16 v[120:135], v[156:159], v[92:95], v[120:135]
    ds_read_b64_tr_b16 v[156:157], v1 offset:64
    ds_read_b64_tr_b16 v[158:159], v1 offset:576
    v_exp_f32 v144, v144
    v_add_f32 v2, v2, v143
    v_cvt_pk_bf16_f32 v139, v142, v143
    v_exp_f32 v145, v145
    s_waitcnt lgkmcnt(5)
    v_mfma_f32_32x32x16_bf16 v[120:135], v[160:163], v[96:99], v[120:135]
    ds_read_b64_tr_b16 v[160:161], v1 offset:128
    ds_read_b64_tr_b16 v[162:163], v1 offset:640
    s_cmp_ge_u32 s28, 4
    s_cbranch_scc1 ld_77
    s_add_u32 m0, s39, 111616
    s_mov_b32 s36, 114688
    buffer_load_dwordx4 v6, s[20:23], s36 offen nt lds
    s_add_u32 m0, s39, 111680
    s_nop 0
    buffer_load_dwordx4 v6, s[20:23], s36 offen offset:1024 nt lds
ld_77:
    v_add_f32 v2, v2, v144
    v_exp_f32 v146, v146
    v_add_f32 v2, v2, v145
    s_waitcnt lgkmcnt(6)
    v_mfma_f32_32x32x16_bf16 v[120:135], v[164:167], v[100:103], v[120:135]
    ds_read_b64_tr_b16 v[164:165], v1 offset:192
    ds_read_b64_tr_b16 v[166:167], v1 offset:704
    v_cvt_pk_bf16_f32 v144, v144, v145
    v_exp_f32 v147, v147
    v_add_f32 v2, v2, v146
    v_exp_f32 v148, v148
    s_setprio 1
    s_waitcnt lgkmcnt(6)
    v_mfma_f32_32x32x16_bf16 v[8:23], v[152:155], v[136:139], v[8:23]
    ds_read_b64_tr_b16 v[152:153], v1 offset:4352
    ds_read_b64_tr_b16 v[154:155], v1 offset:4864
    v_add_f32 v2, v2, v147
    v_cvt_pk_bf16_f32 v145, v146, v147
    v_exp_f32 v149, v149
    s_waitcnt lgkmcnt(6)
    v_mfma_f32_32x32x16_bf16 v[24:39], v[156:159], v[136:139], v[24:39]
    ds_read_b64_tr_b16 v[156:157], v1 offset:4416
    ds_read_b64_tr_b16 v[158:159], v1 offset:4928
    s_cmp_ge_u32 s28, 4
    s_cbranch_scc1 ld_78
    s_add_u32 m0, s39, 120320
    s_mov_b32 s36, 245760
    buffer_load_dwordx4 v6, s[20:23], s36 offen nt lds
    s_add_u32 m0, s39, 120384
    s_nop 0
    buffer_load_dwordx4 v6, s[20:23], s36 offen offset:1024 nt lds
ld_78:
    v_add_f32 v2, v2, v148
    v_exp_f32 v150, v150
    v_add_f32 v2, v2, v149
    v_cvt_pk_bf16_f32 v146, v148, v149
    s_waitcnt lgkmcnt(6)
    v_mfma_f32_32x32x16_bf16 v[40:55], v[160:163], v[136:139], v[40:55]
    ds_read_b64_tr_b16 v[160:161], v1 offset:4480
    ds_read_b64_tr_b16 v[162:163], v1 offset:4992
    v_exp_f32 v151, v151
    v_add_f32 v2, v2, v150
    s_nop 0
    v_add_f32 v2, v2, v151
    s_waitcnt lgkmcnt(6)
    v_mfma_f32_32x32x16_bf16 v[56:71], v[164:167], v[136:139], v[56:71]
    ds_read_b64_tr_b16 v[164:165], v1 offset:4544
    ds_read_b64_tr_b16 v[166:167], v1 offset:5056
    v_cvt_pk_bf16_f32 v147, v150, v151
    s_nop 1
    s_setprio 0
    s_waitcnt lgkmcnt(6)
    v_mfma_f32_32x32x16_bf16 v[8:23], v[152:155], v[144:147], v[8:23]
    ds_read_b128 v[152:155], v0 offset:16896
    v_max3_f32 v3, v120, v121, v122
    v_max3_f32 v3, v3, v123, v124
    v_max3_f32 v3, v3, v125, v126
    s_waitcnt lgkmcnt(5)
    v_mfma_f32_32x32x16_bf16 v[24:39], v[156:159], v[144:147], v[24:39]
    ds_read_b128 v[156:159], v0 offset:16928
    v_max3_f32 v3, v3, v127, v128
    v_max3_f32 v3, v3, v129, v130
    v_max3_f32 v3, v3, v131, v132
    s_waitcnt lgkmcnt(4)
    v_mfma_f32_32x32x16_bf16 v[40:55], v[160:163], v[144:147], v[40:55]
    ds_read_b128 v[160:163], v0 offset:16960
    v_max3_f32 v3, v3, v133, v134
    v_max_f32 v3, v3, v135
    v_cmp_lt_f32 vcc, s34, v3
    s_waitcnt lgkmcnt(3)
    v_mfma_f32_32x32x16_bf16 v[56:71], v[164:167], v[144:147], v[56:71]
    ds_read_b128 v[164:167], v0 offset:16992
    s_cbranch_vccz nr_79
    s_call_b64 s[32:33], standalone__mha_block_cached__near_ridge_kernel_rescale0
nr_79:
    s_waitcnt vmcnt(12)
    s_barrier
    s_setprio 3
    s_waitcnt lgkmcnt(3)
    v_mfma_f32_32x32x16_bf16 v[136:151], v[152:155], v[72:75], v[104:119]
    ds_read_b128 v[152:155], v0 offset:17024
    s_cmp_ge_u32 s28, 4
    s_cbranch_scc1 ld_80
    s_add_u32 m0, s39, 94208
    s_mov_b32 s36, 122880
    buffer_load_dwordx4 v6, s[20:23], s36 offen nt lds
    s_add_u32 m0, s39, 94272
    s_nop 0
    buffer_load_dwordx4 v6, s[20:23], s36 offen offset:1024 nt lds
ld_80:
    v_exp_f32 v120, v120
    v_exp_f32 v121, v121
    v_add_f32 v2, v2, v120
    v_exp_f32 v122, v122
    s_waitcnt lgkmcnt(3)
    v_mfma_f32_32x32x16_bf16 v[136:151], v[156:159], v[76:79], v[136:151]
    ds_read_b128 v[156:159], v0 offset:17056
    v_add_f32 v2, v2, v121
    v_cvt_pk_bf16_f32 v120, v120, v121
    v_exp_f32 v123, v123
    s_waitcnt lgkmcnt(3)
    v_mfma_f32_32x32x16_bf16 v[136:151], v[160:163], v[80:83], v[136:151]
    ds_read_b128 v[160:163], v0 offset:17088
    v_add_f32 v2, v2, v122
    v_exp_f32 v124, v124
    v_add_f32 v2, v2, v123
    v_cvt_pk_bf16_f32 v121, v122, v123
    s_waitcnt lgkmcnt(3)
    v_mfma_f32_32x32x16_bf16 v[136:151], v[164:167], v[84:87], v[136:151]
    ds_read_b128 v[164:167], v0 offset:17120
    s_cmp_ge_u32 s28, 4
    s_cbranch_scc1 ld_81
    s_add_u32 m0, s39, 102912
    s_mov_b32 s36, 253952
    buffer_load_dwordx4 v6, s[20:23], s36 offen nt lds
    s_add_u32 m0, s39, 102976
    s_nop 0
    buffer_load_dwordx4 v6, s[20:23], s36 offen offset:1024 nt lds
ld_81:
    v_exp_f32 v125, v125
    v_add_f32 v2, v2, v124
    v_exp_f32 v126, v126
    s_setprio 2
    s_waitcnt lgkmcnt(3)
    v_mfma_f32_32x32x16_bf16 v[136:151], v[152:155], v[88:91], v[136:151]
    ds_read_b64_tr_b16 v[152:153], v1 offset:52224
    ds_read_b64_tr_b16 v[154:155], v1 offset:52736
    v_add_f32 v2, v2, v125
    v_cvt_pk_bf16_f32 v122, v124, v125
    v_exp_f32 v127, v127
    v_add_f32 v2, v2, v126
    s_waitcnt lgkmcnt(4)
    v_mfma_f32_32x32x16_bf16 v[136:151], v[156:159], v[92:95], v[136:151]
    ds_read_b64_tr_b16 v[156:157], v1 offset:52288
    ds_read_b64_tr_b16 v[158:159], v1 offset:52800
    v_exp_f32 v128, v128
    v_add_f32 v2, v2, v127
    v_cvt_pk_bf16_f32 v123, v126, v127
    v_exp_f32 v129, v129
    s_waitcnt lgkmcnt(5)
    v_mfma_f32_32x32x16_bf16 v[136:151], v[160:163], v[96:99], v[136:151]
    ds_read_b64_tr_b16 v[160:161], v1 offset:52352
    ds_read_b64_tr_b16 v[162:163], v1 offset:52864
    v_add_f32 v2, v2, v128
    v_exp_f32 v130, v130
    v_add_f32 v2, v2, v129
    s_waitcnt lgkmcnt(6)
    v_mfma_f32_32x32x16_bf16 v[136:151], v[164:167], v[100:103], v[136:151]
    ds_read_b64_tr_b16 v[164:165], v1 offset:52416
    ds_read_b64_tr_b16 v[166:167], v1 offset:52928
    v_cvt_pk_bf16_f32 v128, v128, v129
    v_exp_f32 v131, v131
    v_add_f32 v2, v2, v130
    v_exp_f32 v132, v132
    s_setprio 1
    s_waitcnt lgkmcnt(6)
    v_mfma_f32_32x32x16_bf16 v[8:23], v[152:155], v[120:123], v[8:23]
    ds_read_b64_tr_b16 v[152:153], v1 offset:56576
    ds_read_b64_tr_b16 v[154:155], v1 offset:57088
    v_add_f32 v2, v2, v131
    v_cvt_pk_bf16_f32 v129, v130, v131
    v_exp_f32 v133, v133
    s_waitcnt lgkmcnt(6)
    v_mfma_f32_32x32x16_bf16 v[24:39], v[156:159], v[120:123], v[24:39]
    ds_read_b64_tr_b16 v[156:157], v1 offset:56640
    ds_read_b64_tr_b16 v[158:159], v1 offset:57152
    v_add_f32 v2, v2, v132
    v_exp_f32 v134, v134
    v_add_f32 v2, v2, v133
    v_cvt_pk_bf16_f32 v130, v132, v133
    s_waitcnt lgkmcnt(6)
    v_mfma_f32_32x32x16_bf16 v[40:55], v[160:163], v[120:123], v[40:55]
    ds_read_b64_tr_b16 v[160:161], v1 offset:56704
    ds_read_b64_tr_b16 v[162:163], v1 offset:57216
    v_exp_f32 v135, v135
    v_add_f32 v2, v2, v134
    s_nop 0
    v_add_f32 v2, v2, v135
    s_waitcnt lgkmcnt(6)
    v_mfma_f32_32x32x16_bf16 v[56:71], v[164:167], v[120:123], v[56:71]
    ds_read_b64_tr_b16 v[164:165], v1 offset:56768
    ds_read_b64_tr_b16 v[166:167], v1 offset:57280
    v_cvt_pk_bf16_f32 v131, v134, v135
    s_nop 1
    s_setprio 0
    s_waitcnt lgkmcnt(6)
    v_mfma_f32_32x32x16_bf16 v[8:23], v[152:155], v[128:131], v[8:23]
    ds_read_b128 v[152:155], v0 offset:33792
    v_max3_f32 v3, v136, v137, v138
    v_max3_f32 v3, v3, v139, v140
    v_max3_f32 v3, v3, v141, v142
    s_waitcnt lgkmcnt(5)
    v_mfma_f32_32x32x16_bf16 v[24:39], v[156:159], v[128:131], v[24:39]
    ds_read_b128 v[156:159], v0 offset:33824
    v_max3_f32 v3, v3, v143, v144
    v_max3_f32 v3, v3, v145, v146
    v_max3_f32 v3, v3, v147, v148
    s_waitcnt lgkmcnt(4)
    v_mfma_f32_32x32x16_bf16 v[40:55], v[160:163], v[128:131], v[40:55]
    ds_read_b128 v[160:163], v0 offset:33856
    v_max3_f32 v3, v3, v149, v150
    v_max_f32 v3, v3, v151
    v_cmp_lt_f32 vcc, s34, v3
    s_waitcnt lgkmcnt(3)
    v_mfma_f32_32x32x16_bf16 v[56:71], v[164:167], v[128:131], v[56:71]
    ds_read_b128 v[164:167], v0 offset:33888
    s_cbranch_vccz nr_82
    s_call_b64 s[32:33], standalone__mha_block_cached__near_ridge_kernel_rescale1
nr_82:
    s_waitcnt vmcnt(8)
    s_barrier
    s_setprio 3
    s_waitcnt lgkmcnt(3)
    v_mfma_f32_32x32x16_bf16 v[120:135], v[152:155], v[72:75], v[104:119]
    ds_read_b128 v[152:155], v0 offset:33920
    s_cmp_ge_u32 s28, 4
    s_cbranch_scc1 ld_83
    v_lshrrev_b32 v5, 4, v7
    v_lshlrev_b32 v6, 2, v5
    v_xor_b32 v6, v6, v7
    v_and_b32 v6, 15, v6
    v_lshlrev_b32 v6, 4, v6
    v_lshl_add_u32 v5, v5, 10, v6
    s_lshl_b32 s42, s28, 13
    v_add_u32 v5, s42, v5
ld_83:
    v_exp_f32 v136, v136
    v_exp_f32 v137, v137
    v_add_f32 v2, v2, v136
    v_exp_f32 v138, v138
    s_waitcnt lgkmcnt(3)
    v_mfma_f32_32x32x16_bf16 v[120:135], v[156:159], v[76:79], v[120:135]
    ds_read_b128 v[156:159], v0 offset:33952
    v_add_f32 v2, v2, v137
    v_cvt_pk_bf16_f32 v136, v136, v137
    v_exp_f32 v139, v139
    s_waitcnt lgkmcnt(3)
    v_mfma_f32_32x32x16_bf16 v[120:135], v[160:163], v[80:83], v[120:135]
    ds_read_b128 v[160:163], v0 offset:33984
    v_add_f32 v2, v2, v138
    v_exp_f32 v140, v140
    v_add_f32 v2, v2, v139
    v_cvt_pk_bf16_f32 v137, v138, v139
    s_waitcnt lgkmcnt(3)
    v_mfma_f32_32x32x16_bf16 v[120:135], v[164:167], v[84:87], v[120:135]
    ds_read_b128 v[164:167], v0 offset:34016
    s_cmp_ge_u32 s28, 4
    s_cbranch_scc1 ld_84
    s_add_u32 m0, s56, 67584
    s_add_u32 s36, s46, 0
    buffer_load_dwordx4 v5, s[8:11], s36 offen lds
    s_add_u32 m0, s56, 68608
    s_add_u32 s36, s46, 4096
    buffer_load_dwordx4 v5, s[8:11], s36 offen lds
    s_add_u32 m0, s56, 75776
    s_add_u32 s36, s46, 131072
    buffer_load_dwordx4 v5, s[8:11], s36 offen lds
    s_add_u32 m0, s56, 76800
    s_add_u32 s36, s46, 135168
    buffer_load_dwordx4 v5, s[8:11], s36 offen lds
ld_84:
    v_exp_f32 v141, v141
    v_add_f32 v2, v2, v140
    v_exp_f32 v142, v142
    s_setprio 2
    s_waitcnt lgkmcnt(3)
    v_mfma_f32_32x32x16_bf16 v[120:135], v[152:155], v[88:91], v[120:135]
    ds_read_b64_tr_b16 v[152:153], v1 offset:34816
    ds_read_b64_tr_b16 v[154:155], v1 offset:35328
    v_add_f32 v2, v2, v141
    v_cvt_pk_bf16_f32 v138, v140, v141
    v_exp_f32 v143, v143
    v_add_f32 v2, v2, v142
    s_waitcnt lgkmcnt(4)
    v_mfma_f32_32x32x16_bf16 v[120:135], v[156:159], v[92:95], v[120:135]
    ds_read_b64_tr_b16 v[156:157], v1 offset:34880
    ds_read_b64_tr_b16 v[158:159], v1 offset:35392
    v_exp_f32 v144, v144
    v_add_f32 v2, v2, v143
    v_cvt_pk_bf16_f32 v139, v142, v143
    v_exp_f32 v145, v145
    s_waitcnt lgkmcnt(5)
    v_mfma_f32_32x32x16_bf16 v[120:135], v[160:163], v[96:99], v[120:135]
    ds_read_b64_tr_b16 v[160:161], v1 offset:34944
    ds_read_b64_tr_b16 v[162:163], v1 offset:35456
    s_cmp_ge_u32 s28, 4
    s_cbranch_scc1 ld_85
    s_add_u32 m0, s56, 0
    s_add_u32 s36, s46, 32768
    buffer_load_dwordx4 v5, s[8:11], s36 offen lds
    s_add_u32 m0, s56, 1024
    s_add_u32 s36, s46, 36864
    buffer_load_dwordx4 v5, s[8:11], s36 offen lds
    s_add_u32 m0, s56, 8192
    s_add_u32 s36, s46, 163840
    buffer_load_dwordx4 v5, s[8:11], s36 offen lds
    s_add_u32 m0, s56, 9216
    s_add_u32 s36, s46, 167936
    buffer_load_dwordx4 v5, s[8:11], s36 offen lds
ld_85:
    v_add_f32 v2, v2, v144
    v_exp_f32 v146, v146
    v_add_f32 v2, v2, v145
    s_waitcnt lgkmcnt(6)
    v_mfma_f32_32x32x16_bf16 v[120:135], v[164:167], v[100:103], v[120:135]
    ds_read_b64_tr_b16 v[164:165], v1 offset:35008
    ds_read_b64_tr_b16 v[166:167], v1 offset:35520
    v_cvt_pk_bf16_f32 v144, v144, v145
    v_exp_f32 v147, v147
    v_add_f32 v2, v2, v146
    v_exp_f32 v148, v148
    s_setprio 1
    s_waitcnt lgkmcnt(6)
    v_mfma_f32_32x32x16_bf16 v[8:23], v[152:155], v[136:139], v[8:23]
    ds_read_b64_tr_b16 v[152:153], v1 offset:39168
    ds_read_b64_tr_b16 v[154:155], v1 offset:39680
    v_add_f32 v2, v2, v147
    v_cvt_pk_bf16_f32 v145, v146, v147
    v_exp_f32 v149, v149
    s_waitcnt lgkmcnt(6)
    v_mfma_f32_32x32x16_bf16 v[24:39], v[156:159], v[136:139], v[24:39]
    ds_read_b64_tr_b16 v[156:157], v1 offset:39232
    ds_read_b64_tr_b16 v[158:159], v1 offset:39744
    s_cmp_ge_u32 s28, 4
    s_cbranch_scc1 ld_86
    s_add_u32 m0, s56, 16384
    s_add_u32 s36, s46, 65536
    buffer_load_dwordx4 v5, s[8:11], s36 offen lds
    s_add_u32 m0, s56, 17408
    s_add_u32 s36, s46, 69632
    buffer_load_dwordx4 v5, s[8:11], s36 offen lds
    s_add_u32 m0, s56, 24576
    s_add_u32 s36, s46, 196608
    buffer_load_dwordx4 v5, s[8:11], s36 offen lds
    s_add_u32 m0, s56, 25600
    s_add_u32 s36, s46, 200704
    buffer_load_dwordx4 v5, s[8:11], s36 offen lds
ld_86:
    v_add_f32 v2, v2, v148
    v_exp_f32 v150, v150
    v_add_f32 v2, v2, v149
    v_cvt_pk_bf16_f32 v146, v148, v149
    s_waitcnt lgkmcnt(6)
    v_mfma_f32_32x32x16_bf16 v[40:55], v[160:163], v[136:139], v[40:55]
    ds_read_b64_tr_b16 v[160:161], v1 offset:39296
    ds_read_b64_tr_b16 v[162:163], v1 offset:39808
    v_exp_f32 v151, v151
    v_add_f32 v2, v2, v150
    s_nop 0
    v_add_f32 v2, v2, v151
    s_waitcnt lgkmcnt(6)
    v_mfma_f32_32x32x16_bf16 v[56:71], v[164:167], v[136:139], v[56:71]
    ds_read_b64_tr_b16 v[164:165], v1 offset:39360
    ds_read_b64_tr_b16 v[166:167], v1 offset:39872
    v_cvt_pk_bf16_f32 v147, v150, v151
    s_nop 1
    s_setprio 0
    s_waitcnt lgkmcnt(6)
    v_mfma_f32_32x32x16_bf16 v[8:23], v[152:155], v[144:147], v[8:23]
    ds_read_b128 v[152:155], v0 offset:50688
    s_cmp_ge_u32 s28, 4
    s_cbranch_scc1 ld_87
    s_add_u32 m0, s56, 147456
    s_add_u32 s36, s46, 98304
    buffer_load_dwordx4 v5, s[8:11], s36 offen lds
    s_add_u32 m0, s56, 148480
    s_add_u32 s36, s46, 102400
    buffer_load_dwordx4 v5, s[8:11], s36 offen lds
    s_add_u32 m0, s56, 155648
    s_add_u32 s36, s46, 229376
    buffer_load_dwordx4 v5, s[8:11], s36 offen lds
    s_add_u32 m0, s56, 156672
    s_add_u32 s36, s46, 233472
    buffer_load_dwordx4 v5, s[8:11], s36 offen lds
ld_87:
    v_max3_f32 v3, v120, v121, v122
    v_max3_f32 v3, v3, v123, v124
    v_max3_f32 v3, v3, v125, v126
    s_waitcnt lgkmcnt(5)
    v_mfma_f32_32x32x16_bf16 v[24:39], v[156:159], v[144:147], v[24:39]
    ds_read_b128 v[156:159], v0 offset:50720
    v_max3_f32 v3, v3, v127, v128
    v_max3_f32 v3, v3, v129, v130
    v_max3_f32 v3, v3, v131, v132
    s_waitcnt lgkmcnt(4)
    v_mfma_f32_32x32x16_bf16 v[40:55], v[160:163], v[144:147], v[40:55]
    ds_read_b128 v[160:163], v0 offset:50752
    v_max3_f32 v3, v3, v133, v134
    v_max_f32 v3, v3, v135
    v_cmp_lt_f32 vcc, s34, v3
    s_waitcnt lgkmcnt(3)
    v_mfma_f32_32x32x16_bf16 v[56:71], v[164:167], v[144:147], v[56:71]
    ds_read_b128 v[164:167], v0 offset:50784
    s_cbranch_vccz nr_88
    s_call_b64 s[32:33], standalone__mha_block_cached__near_ridge_kernel_rescale0
nr_88:
    s_waitcnt vmcnt(16)
    s_barrier
    s_setprio 3
    s_waitcnt lgkmcnt(3)
    v_mfma_f32_32x32x16_bf16 v[136:151], v[152:155], v[72:75], v[104:119]
    ds_read_b128 v[152:155], v0 offset:50816
    s_cmp_ge_u32 s28, 4
    s_cbranch_scc1 ld_89
    s_add_u32 m0, s56, 32768
    s_add_u32 s36, s47, 0
    buffer_load_dwordx4 v5, s[8:11], s36 offen lds
    s_add_u32 m0, s56, 33792
    s_add_u32 s36, s47, 4096
    buffer_load_dwordx4 v5, s[8:11], s36 offen lds
    s_add_u32 m0, s56, 40960
    s_add_u32 s36, s47, 131072
    buffer_load_dwordx4 v5, s[8:11], s36 offen lds
    s_add_u32 m0, s56, 41984
    s_add_u32 s36, s47, 135168
    buffer_load_dwordx4 v5, s[8:11], s36 offen lds
ld_89:
    v_exp_f32 v120, v120
    v_exp_f32 v121, v121
    v_add_f32 v2, v2, v120
    v_exp_f32 v122, v122
    s_waitcnt lgkmcnt(3)
    v_mfma_f32_32x32x16_bf16 v[136:151], v[156:159], v[76:79], v[136:151]
    ds_read_b128 v[156:159], v0 offset:50848
    v_add_f32 v2, v2, v121
    v_cvt_pk_bf16_f32 v120, v120, v121
    v_exp_f32 v123, v123
    s_waitcnt lgkmcnt(3)
    v_mfma_f32_32x32x16_bf16 v[136:151], v[160:163], v[80:83], v[136:151]
    ds_read_b128 v[160:163], v0 offset:50880
    v_add_f32 v2, v2, v122
    v_exp_f32 v124, v124
    v_add_f32 v2, v2, v123
    v_cvt_pk_bf16_f32 v121, v122, v123
    s_waitcnt lgkmcnt(3)
    v_mfma_f32_32x32x16_bf16 v[136:151], v[164:167], v[84:87], v[136:151]
    ds_read_b128 v[164:167], v0 offset:50912
    s_cmp_ge_u32 s28, 4
    s_cbranch_scc1 ld_90
    s_add_u32 m0, s56, 131072
    s_add_u32 s36, s47, 32768
    buffer_load_dwordx4 v5, s[8:11], s36 offen lds
    s_add_u32 m0, s56, 132096
    s_add_u32 s36, s47, 36864
    buffer_load_dwordx4 v5, s[8:11], s36 offen lds
    s_add_u32 m0, s56, 139264
    s_add_u32 s36, s47, 163840
    buffer_load_dwordx4 v5, s[8:11], s36 offen lds
    s_add_u32 m0, s56, 140288
    s_add_u32 s36, s47, 167936
    buffer_load_dwordx4 v5, s[8:11], s36 offen lds
ld_90:
    v_exp_f32 v125, v125
    v_add_f32 v2, v2, v124
    v_exp_f32 v126, v126
    s_setprio 2
    s_waitcnt lgkmcnt(3)
    v_mfma_f32_32x32x16_bf16 v[136:151], v[152:155], v[88:91], v[136:151]
    ds_read_b64_tr_b16 v[152:153], v1 offset:17408
    ds_read_b64_tr_b16 v[154:155], v1 offset:17920
    v_add_f32 v2, v2, v125
    v_cvt_pk_bf16_f32 v122, v124, v125
    v_exp_f32 v127, v127
    v_add_f32 v2, v2, v126
    s_waitcnt lgkmcnt(4)
    v_mfma_f32_32x32x16_bf16 v[136:151], v[156:159], v[92:95], v[136:151]
    ds_read_b64_tr_b16 v[156:157], v1 offset:17472
    ds_read_b64_tr_b16 v[158:159], v1 offset:17984
    v_exp_f32 v128, v128
    v_add_f32 v2, v2, v127
    v_cvt_pk_bf16_f32 v123, v126, v127
    v_exp_f32 v129, v129
    s_waitcnt lgkmcnt(5)
    v_mfma_f32_32x32x16_bf16 v[136:151], v[160:163], v[96:99], v[136:151]
    ds_read_b64_tr_b16 v[160:161], v1 offset:17536
    ds_read_b64_tr_b16 v[162:163], v1 offset:18048
    v_add_f32 v2, v2, v128
    v_exp_f32 v130, v130
    v_add_f32 v2, v2, v129
    s_waitcnt lgkmcnt(6)
    v_mfma_f32_32x32x16_bf16 v[136:151], v[164:167], v[100:103], v[136:151]
    ds_read_b64_tr_b16 v[164:165], v1 offset:17600
    ds_read_b64_tr_b16 v[166:167], v1 offset:18112
    v_cvt_pk_bf16_f32 v128, v128, v129
    v_exp_f32 v131, v131
    v_add_f32 v2, v2, v130
    v_exp_f32 v132, v132
    s_setprio 1
    s_waitcnt lgkmcnt(6)
    v_mfma_f32_32x32x16_bf16 v[8:23], v[152:155], v[120:123], v[8:23]
    ds_read_b64_tr_b16 v[152:153], v1 offset:21760
    ds_read_b64_tr_b16 v[154:155], v1 offset:22272
    v_add_f32 v2, v2, v131
    v_cvt_pk_bf16_f32 v129, v130, v131
    v_exp_f32 v133, v133
    s_waitcnt lgkmcnt(6)
    v_mfma_f32_32x32x16_bf16 v[24:39], v[156:159], v[120:123], v[24:39]
    ds_read_b64_tr_b16 v[156:157], v1 offset:21824
    ds_read_b64_tr_b16 v[158:159], v1 offset:22336
    v_add_f32 v2, v2, v132
    v_exp_f32 v134, v134
    v_add_f32 v2, v2, v133
    v_cvt_pk_bf16_f32 v130, v132, v133
    s_waitcnt lgkmcnt(6)
    v_mfma_f32_32x32x16_bf16 v[40:55], v[160:163], v[120:123], v[40:55]
    ds_read_b64_tr_b16 v[160:161], v1 offset:21888
    ds_read_b64_tr_b16 v[162:163], v1 offset:22400
    v_exp_f32 v135, v135
    v_add_f32 v2, v2, v134
    s_nop 0
    v_add_f32 v2, v2, v135
    s_waitcnt lgkmcnt(6)
    v_mfma_f32_32x32x16_bf16 v[56:71], v[164:167], v[120:123], v[56:71]
    ds_read_b64_tr_b16 v[164:165], v1 offset:21952
    ds_read_b64_tr_b16 v[166:167], v1 offset:22464
    v_cvt_pk_bf16_f32 v131, v134, v135
    s_nop 1
    s_setprio 0
    s_waitcnt lgkmcnt(6)
    v_mfma_f32_32x32x16_bf16 v[8:23], v[152:155], v[128:131], v[8:23]
    ds_read_b64_tr_b16 v[152:153], v1 offset:0
    ds_read_b64_tr_b16 v[154:155], v1 offset:512
    v_max3_f32 v3, v136, v137, v138
    v_max3_f32 v3, v3, v139, v140
    v_max3_f32 v3, v3, v141, v142
    s_waitcnt lgkmcnt(6)
    v_mfma_f32_32x32x16_bf16 v[24:39], v[156:159], v[128:131], v[24:39]
    ds_read_b64_tr_b16 v[156:157], v1 offset:64
    ds_read_b64_tr_b16 v[158:159], v1 offset:576
    v_max3_f32 v3, v3, v143, v144
    v_max3_f32 v3, v3, v145, v146
    v_max3_f32 v3, v3, v147, v148
    s_waitcnt lgkmcnt(6)
    v_mfma_f32_32x32x16_bf16 v[40:55], v[160:163], v[128:131], v[40:55]
    ds_read_b64_tr_b16 v[160:161], v1 offset:128
    ds_read_b64_tr_b16 v[162:163], v1 offset:640
    v_max3_f32 v3, v3, v149, v150
    v_max_f32 v3, v3, v151
    v_cmp_lt_f32 vcc, s34, v3
    s_waitcnt lgkmcnt(6)
    v_mfma_f32_32x32x16_bf16 v[56:71], v[164:167], v[128:131], v[56:71]
    ds_read_b64_tr_b16 v[164:165], v1 offset:192
    ds_read_b64_tr_b16 v[166:167], v1 offset:704
    s_cbranch_vccz nr_91
    s_call_b64 s[32:33], standalone__mha_block_cached__near_ridge_kernel_rescale1
nr_91:
    s_barrier
    v_exp_f32 v136, v136
    v_exp_f32 v137, v137
    v_add_f32 v2, v2, v136
    v_exp_f32 v138, v138
    v_add_f32 v2, v2, v137
    v_cvt_pk_bf16_f32 v136, v136, v137
    v_exp_f32 v139, v139
    v_add_f32 v2, v2, v138
    v_exp_f32 v140, v140
    v_add_f32 v2, v2, v139
    v_cvt_pk_bf16_f32 v137, v138, v139
    v_exp_f32 v141, v141
    v_add_f32 v2, v2, v140
    v_exp_f32 v142, v142
    v_add_f32 v2, v2, v141
    v_cvt_pk_bf16_f32 v138, v140, v141
    v_exp_f32 v143, v143
    v_add_f32 v2, v2, v142
    v_exp_f32 v144, v144
    v_add_f32 v2, v2, v143
    v_cvt_pk_bf16_f32 v139, v142, v143
    v_exp_f32 v145, v145
    v_add_f32 v2, v2, v144
    s_waitcnt lgkmcnt(6)
    v_mfma_f32_32x32x16_bf16 v[8:23], v[152:155], v[136:139], v[8:23]
    ds_read_b64_tr_b16 v[152:153], v1 offset:4352
    ds_read_b64_tr_b16 v[154:155], v1 offset:4864
    s_cmp_ge_u32 s28, 4
    s_cbranch_scc1 ld_92
    s_add_u32 m0, s56, 49152
    s_add_u32 s36, s47, 65536
    buffer_load_dwordx4 v5, s[8:11], s36 offen lds
    s_add_u32 m0, s56, 50176
    s_add_u32 s36, s47, 69632
    buffer_load_dwordx4 v5, s[8:11], s36 offen lds
    s_add_u32 m0, s56, 57344
    s_add_u32 s36, s47, 196608
    buffer_load_dwordx4 v5, s[8:11], s36 offen lds
    s_add_u32 m0, s56, 58368
    s_add_u32 s36, s47, 200704
    buffer_load_dwordx4 v5, s[8:11], s36 offen lds
ld_92:
    v_exp_f32 v146, v146
    v_add_f32 v2, v2, v145
    v_cvt_pk_bf16_f32 v144, v144, v145
    v_exp_f32 v147, v147
    v_add_f32 v2, v2, v146
    s_waitcnt lgkmcnt(6)
    v_mfma_f32_32x32x16_bf16 v[24:39], v[156:159], v[136:139], v[24:39]
    ds_read_b64_tr_b16 v[156:157], v1 offset:4416
    ds_read_b64_tr_b16 v[158:159], v1 offset:4928
    s_cmp_ge_u32 s28, 4
    s_cbranch_scc1 ld_93
    s_add_u32 m0, s56, 114688
    s_add_u32 s36, s47, 98304
    buffer_load_dwordx4 v5, s[8:11], s36 offen lds
    s_add_u32 m0, s56, 115712
    s_add_u32 s36, s47, 102400
    buffer_load_dwordx4 v5, s[8:11], s36 offen lds
    s_add_u32 m0, s56, 122880
    s_add_u32 s36, s47, 229376
    buffer_load_dwordx4 v5, s[8:11], s36 offen lds
    s_add_u32 m0, s56, 123904
    s_add_u32 s36, s47, 233472
    buffer_load_dwordx4 v5, s[8:11], s36 offen lds
ld_93:
    v_exp_f32 v148, v148
    v_add_f32 v2, v2, v147
    v_cvt_pk_bf16_f32 v145, v146, v147
    v_exp_f32 v149, v149
    v_add_f32 v2, v2, v148
    v_exp_f32 v150, v150
    s_waitcnt lgkmcnt(6)
    v_mfma_f32_32x32x16_bf16 v[40:55], v[160:163], v[136:139], v[40:55]
    ds_read_b64_tr_b16 v[160:161], v1 offset:4480
    ds_read_b64_tr_b16 v[162:163], v1 offset:4992
    v_add_f32 v2, v2, v149
    v_cvt_pk_bf16_f32 v146, v148, v149
    v_exp_f32 v151, v151
    v_add_f32 v2, v2, v150
    s_nop 0
    s_waitcnt lgkmcnt(6)
    v_mfma_f32_32x32x16_bf16 v[56:71], v[164:167], v[136:139], v[56:71]
    ds_read_b64_tr_b16 v[164:165], v1 offset:4544
    ds_read_b64_tr_b16 v[166:167], v1 offset:5056
    v_add_f32 v2, v2, v151
    v_cvt_pk_bf16_f32 v147, v150, v151
    s_nop 1
    s_waitcnt lgkmcnt(6)
    v_mfma_f32_32x32x16_bf16 v[8:23], v[152:155], v[144:147], v[8:23]
    s_waitcnt lgkmcnt(4)
    v_mfma_f32_32x32x16_bf16 v[24:39], v[156:159], v[144:147], v[24:39]
    s_waitcnt lgkmcnt(2)
    v_mfma_f32_32x32x16_bf16 v[40:55], v[160:163], v[144:147], v[40:55]
    s_waitcnt lgkmcnt(0)
    v_mfma_f32_32x32x16_bf16 v[56:71], v[164:167], v[144:147], v[56:71]
    v_mov_b32 v3, v2
    s_nop 1
    v_permlane32_swap_b32 v3, v2
    s_nop 1
    v_add_f32 v2, v2, v3
    v_rcp_f32 v2, v2
    s_nop 3
    v_mov_b32 v3, v2
    v_lshlrev_b32 v4, 4, v7
    s_add_u32 s58, s50, 4096
    v_pk_mul_f32 v[8:9], v[8:9], v[2:3]
    v_pk_mul_f32 v[10:11], v[10:11], v[2:3]
    v_pk_mul_f32 v[12:13], v[12:13], v[2:3]
    v_pk_mul_f32 v[14:15], v[14:15], v[2:3]
    v_cvt_pk_bf16_f32 v72, v8, v9
    v_cvt_pk_bf16_f32 v73, v10, v11
    v_cvt_pk_bf16_f32 v74, v12, v13
    v_cvt_pk_bf16_f32 v75, v14, v15
    buffer_store_dwordx4 v[72:75], v4, s[24:27], s50 offen offset:0 sc1
    v_pk_mul_f32 v[16:17], v[16:17], v[2:3]
    v_pk_mul_f32 v[18:19], v[18:19], v[2:3]
    v_pk_mul_f32 v[20:21], v[20:21], v[2:3]
    v_pk_mul_f32 v[22:23], v[22:23], v[2:3]
    v_cvt_pk_bf16_f32 v76, v16, v17
    v_cvt_pk_bf16_f32 v77, v18, v19
    v_cvt_pk_bf16_f32 v78, v20, v21
    v_cvt_pk_bf16_f32 v79, v22, v23
    buffer_store_dwordx4 v[76:79], v4, s[24:27], s50 offen offset:1024 sc1
    v_pk_mul_f32 v[24:25], v[24:25], v[2:3]
    v_pk_mul_f32 v[26:27], v[26:27], v[2:3]
    v_pk_mul_f32 v[28:29], v[28:29], v[2:3]
    v_pk_mul_f32 v[30:31], v[30:31], v[2:3]
    v_cvt_pk_bf16_f32 v80, v24, v25
    v_cvt_pk_bf16_f32 v81, v26, v27
    v_cvt_pk_bf16_f32 v82, v28, v29
    v_cvt_pk_bf16_f32 v83, v30, v31
    buffer_store_dwordx4 v[80:83], v4, s[24:27], s50 offen offset:2048 sc1
    v_pk_mul_f32 v[32:33], v[32:33], v[2:3]
    v_pk_mul_f32 v[34:35], v[34:35], v[2:3]
    v_pk_mul_f32 v[36:37], v[36:37], v[2:3]
    v_pk_mul_f32 v[38:39], v[38:39], v[2:3]
    v_cvt_pk_bf16_f32 v84, v32, v33
    v_cvt_pk_bf16_f32 v85, v34, v35
    v_cvt_pk_bf16_f32 v86, v36, v37
    v_cvt_pk_bf16_f32 v87, v38, v39
    buffer_store_dwordx4 v[84:87], v4, s[24:27], s50 offen offset:3072 sc1
    v_pk_mul_f32 v[40:41], v[40:41], v[2:3]
    v_pk_mul_f32 v[42:43], v[42:43], v[2:3]
    v_pk_mul_f32 v[44:45], v[44:45], v[2:3]
    v_pk_mul_f32 v[46:47], v[46:47], v[2:3]
    v_cvt_pk_bf16_f32 v88, v40, v41
    v_cvt_pk_bf16_f32 v89, v42, v43
    v_cvt_pk_bf16_f32 v90, v44, v45
    v_cvt_pk_bf16_f32 v91, v46, v47
    v_pk_mul_f32 v[48:49], v[48:49], v[2:3]
    v_pk_mul_f32 v[50:51], v[50:51], v[2:3]
    v_pk_mul_f32 v[52:53], v[52:53], v[2:3]
    v_pk_mul_f32 v[54:55], v[54:55], v[2:3]
    v_cvt_pk_bf16_f32 v92, v48, v49
    v_cvt_pk_bf16_f32 v93, v50, v51
    v_cvt_pk_bf16_f32 v94, v52, v53
    v_cvt_pk_bf16_f32 v95, v54, v55
    v_pk_mul_f32 v[56:57], v[56:57], v[2:3]
    v_pk_mul_f32 v[58:59], v[58:59], v[2:3]
    v_pk_mul_f32 v[60:61], v[60:61], v[2:3]
    v_pk_mul_f32 v[62:63], v[62:63], v[2:3]
    v_cvt_pk_bf16_f32 v96, v56, v57
    v_cvt_pk_bf16_f32 v97, v58, v59
    v_cvt_pk_bf16_f32 v98, v60, v61
    v_cvt_pk_bf16_f32 v99, v62, v63
    v_pk_mul_f32 v[64:65], v[64:65], v[2:3]
    v_pk_mul_f32 v[66:67], v[66:67], v[2:3]
    v_pk_mul_f32 v[68:69], v[68:69], v[2:3]
    v_pk_mul_f32 v[70:71], v[70:71], v[2:3]
    v_cvt_pk_bf16_f32 v100, v64, v65
    v_cvt_pk_bf16_f32 v101, v66, v67
    v_cvt_pk_bf16_f32 v102, v68, v69
    v_cvt_pk_bf16_f32 v103, v70, v71
    v_and_b32 v136, 16, v7
    v_lshlrev_b32 v136, 1, v136
    v_and_b32 v139, 1, v7
    v_lshl_add_u32 v136, v139, 4, v136
    v_and_b32 v139, 2, v7
    v_lshl_add_u32 v136, v139, 2, v136
    v_bfe_u32 v137, v7, 2, 2
    v_lshrrev_b32 v138, 5, v7
    v_lshl_add_u32 v139, v138, 3, v137
    v_lshl_add_u32 v139, v139, 8, v136
    s_lshl_b32 s42, s29, 13
    s_add_u32 s42, s42, 67584
    v_add_u32 v139, s42, v139
    s_lshl_b32 s42, s29, 1
    v_xor_b32 v137, s42, v137
    v_xor_b32 v140, 0, v137
    v_lshl_add_u32 v0, v140, 6, v139
    v_xor_b32 v140, 1, v137
    v_lshl_add_u32 v1, v140, 6, v139
    v_xor_b32 v140, 2, v137
    v_lshl_add_u32 v2, v140, 6, v139
    v_xor_b32 v140, 3, v137
    v_lshl_add_u32 v3, v140, 6, v139
    s_waitcnt vmcnt(4)
    s_barrier
    ds_read_b64_tr_b16 v[136:137], v0 offset:0
    ds_read_b64_tr_b16 v[138:139], v0 offset:1024
    ds_read_b64_tr_b16 v[140:141], v1 offset:0
    ds_read_b64_tr_b16 v[142:143], v1 offset:1024
    ds_read_b64_tr_b16 v[144:145], v2 offset:0
    ds_read_b64_tr_b16 v[146:147], v2 offset:1024
    ds_read_b64_tr_b16 v[148:149], v3 offset:0
    ds_read_b64_tr_b16 v[150:151], v3 offset:1024
    ds_read_b64_tr_b16 v[152:153], v0 offset:4096
    ds_read_b64_tr_b16 v[154:155], v0 offset:5120
    ds_read_b64_tr_b16 v[156:157], v1 offset:4096
    ds_read_b64_tr_b16 v[158:159], v1 offset:5120
    ds_read_b64_tr_b16 v[160:161], v2 offset:4096
    ds_read_b64_tr_b16 v[162:163], v2 offset:5120
    s_waitcnt lgkmcnt(12)
    v_mfma_f32_32x32x16_bf16 v[8:23], v[136:139], v[72:75], 0
    ds_read_b64_tr_b16 v[164:165], v3 offset:4096
    ds_read_b64_tr_b16 v[166:167], v3 offset:5120
    buffer_store_dwordx4 v[88:91], v4, s[24:27], s58 offen offset:0 sc1
    s_waitcnt lgkmcnt(12)
    v_mfma_f32_32x32x16_bf16 v[24:39], v[140:143], v[72:75], 0
    v_add_u32 v0, 0xfffef800, v0
    ds_read_b64_tr_b16 v[136:137], v0 offset:0
    ds_read_b64_tr_b16 v[138:139], v0 offset:1024
    s_waitcnt lgkmcnt(12)
    v_mfma_f32_32x32x16_bf16 v[40:55], v[144:147], v[72:75], 0
    v_add_u32 v1, 0xfffef800, v1
    ds_read_b64_tr_b16 v[140:141], v1 offset:0
    ds_read_b64_tr_b16 v[142:143], v1 offset:1024
    buffer_store_dwordx4 v[92:95], v4, s[24:27], s58 offen offset:1024 sc1
    s_waitcnt lgkmcnt(12)
    v_mfma_f32_32x32x16_bf16 v[56:71], v[148:151], v[72:75], 0
    v_add_u32 v2, 0xfffef800, v2
    ds_read_b64_tr_b16 v[144:145], v2 offset:0
    ds_read_b64_tr_b16 v[146:147], v2 offset:1024
    s_waitcnt lgkmcnt(12)
    v_mfma_f32_32x32x16_bf16 v[8:23], v[152:155], v[76:79], v[8:23]
    v_add_u32 v3, 0xfffef800, v3
    ds_read_b64_tr_b16 v[148:149], v3 offset:0
    ds_read_b64_tr_b16 v[150:151], v3 offset:1024
    buffer_store_dwordx4 v[96:99], v4, s[24:27], s58 offen offset:2048 sc1
    s_waitcnt lgkmcnt(12)
    v_mfma_f32_32x32x16_bf16 v[24:39], v[156:159], v[76:79], v[24:39]
    ds_read_b64_tr_b16 v[152:153], v0 offset:4096
    ds_read_b64_tr_b16 v[154:155], v0 offset:5120
    s_waitcnt lgkmcnt(12)
    v_mfma_f32_32x32x16_bf16 v[40:55], v[160:163], v[76:79], v[40:55]
    ds_read_b64_tr_b16 v[156:157], v1 offset:4096
    ds_read_b64_tr_b16 v[158:159], v1 offset:5120
    buffer_store_dwordx4 v[100:103], v4, s[24:27], s58 offen offset:3072 sc1
    s_waitcnt lgkmcnt(12)
    v_mfma_f32_32x32x16_bf16 v[56:71], v[164:167], v[76:79], v[56:71]
    ds_read_b64_tr_b16 v[160:161], v2 offset:4096
    ds_read_b64_tr_b16 v[162:163], v2 offset:5120
    s_waitcnt lgkmcnt(12)
    v_mfma_f32_32x32x16_bf16 v[8:23], v[136:139], v[80:83], v[8:23]
    ds_read_b64_tr_b16 v[164:165], v3 offset:4096
    ds_read_b64_tr_b16 v[166:167], v3 offset:5120
    s_waitcnt lgkmcnt(12)
    v_mfma_f32_32x32x16_bf16 v[24:39], v[140:143], v[80:83], v[24:39]
    v_add_u32 v0, 0x4000, v0
    ds_read_b64_tr_b16 v[136:137], v0 offset:0
    ds_read_b64_tr_b16 v[138:139], v0 offset:1024
    s_waitcnt lgkmcnt(12)
    v_mfma_f32_32x32x16_bf16 v[40:55], v[144:147], v[80:83], v[40:55]
    v_add_u32 v1, 0x4000, v1
    ds_read_b64_tr_b16 v[140:141], v1 offset:0
    ds_read_b64_tr_b16 v[142:143], v1 offset:1024
    s_waitcnt lgkmcnt(12)
    v_mfma_f32_32x32x16_bf16 v[56:71], v[148:151], v[80:83], v[56:71]
    v_add_u32 v2, 0x4000, v2
    ds_read_b64_tr_b16 v[144:145], v2 offset:0
    ds_read_b64_tr_b16 v[146:147], v2 offset:1024
    s_waitcnt lgkmcnt(12)
    v_mfma_f32_32x32x16_bf16 v[8:23], v[152:155], v[84:87], v[8:23]
    v_add_u32 v3, 0x4000, v3
    ds_read_b64_tr_b16 v[148:149], v3 offset:0
    ds_read_b64_tr_b16 v[150:151], v3 offset:1024
    s_waitcnt lgkmcnt(12)
    v_mfma_f32_32x32x16_bf16 v[24:39], v[156:159], v[84:87], v[24:39]
    ds_read_b64_tr_b16 v[152:153], v0 offset:4096
    ds_read_b64_tr_b16 v[154:155], v0 offset:5120
    s_waitcnt lgkmcnt(12)
    v_mfma_f32_32x32x16_bf16 v[40:55], v[160:163], v[84:87], v[40:55]
    ds_read_b64_tr_b16 v[156:157], v1 offset:4096
    ds_read_b64_tr_b16 v[158:159], v1 offset:5120
    s_waitcnt lgkmcnt(12)
    v_mfma_f32_32x32x16_bf16 v[56:71], v[164:167], v[84:87], v[56:71]
    ds_read_b64_tr_b16 v[160:161], v2 offset:4096
    ds_read_b64_tr_b16 v[162:163], v2 offset:5120
    s_waitcnt lgkmcnt(12)
    v_mfma_f32_32x32x16_bf16 v[8:23], v[136:139], v[88:91], v[8:23]
    ds_read_b64_tr_b16 v[164:165], v3 offset:4096
    ds_read_b64_tr_b16 v[166:167], v3 offset:5120
    s_waitcnt lgkmcnt(12)
    v_mfma_f32_32x32x16_bf16 v[24:39], v[140:143], v[88:91], v[24:39]
    v_add_u32 v0, 0x20000, v0
    ds_read_b64_tr_b16 v[136:137], v0 offset:0
    ds_read_b64_tr_b16 v[138:139], v0 offset:1024
    s_waitcnt lgkmcnt(12)
    v_mfma_f32_32x32x16_bf16 v[40:55], v[144:147], v[88:91], v[40:55]
    v_add_u32 v1, 0x20000, v1
    ds_read_b64_tr_b16 v[140:141], v1 offset:0
    ds_read_b64_tr_b16 v[142:143], v1 offset:1024
    s_waitcnt lgkmcnt(12)
    v_mfma_f32_32x32x16_bf16 v[56:71], v[148:151], v[88:91], v[56:71]
    v_add_u32 v2, 0x20000, v2
    ds_read_b64_tr_b16 v[144:145], v2 offset:0
    ds_read_b64_tr_b16 v[146:147], v2 offset:1024
    s_waitcnt lgkmcnt(12)
    v_mfma_f32_32x32x16_bf16 v[8:23], v[152:155], v[92:95], v[8:23]
    v_add_u32 v3, 0x20000, v3
    ds_read_b64_tr_b16 v[148:149], v3 offset:0
    ds_read_b64_tr_b16 v[150:151], v3 offset:1024
    s_waitcnt lgkmcnt(12)
    v_mfma_f32_32x32x16_bf16 v[24:39], v[156:159], v[92:95], v[24:39]
    ds_read_b64_tr_b16 v[152:153], v0 offset:4096
    ds_read_b64_tr_b16 v[154:155], v0 offset:5120
    s_waitcnt lgkmcnt(12)
    v_mfma_f32_32x32x16_bf16 v[40:55], v[160:163], v[92:95], v[40:55]
    ds_read_b64_tr_b16 v[156:157], v1 offset:4096
    ds_read_b64_tr_b16 v[158:159], v1 offset:5120
    s_waitcnt lgkmcnt(12)
    v_mfma_f32_32x32x16_bf16 v[56:71], v[164:167], v[92:95], v[56:71]
    ds_read_b64_tr_b16 v[160:161], v2 offset:4096
    ds_read_b64_tr_b16 v[162:163], v2 offset:5120
    s_waitcnt lgkmcnt(12)
    v_mfma_f32_32x32x16_bf16 v[8:23], v[136:139], v[96:99], v[8:23]
    ds_read_b64_tr_b16 v[164:165], v3 offset:4096
    ds_read_b64_tr_b16 v[166:167], v3 offset:5120
    s_waitcnt lgkmcnt(12)
    v_mfma_f32_32x32x16_bf16 v[24:39], v[140:143], v[96:99], v[24:39]
    v_add_u32 v0, 0xfffe4000, v0
    ds_read_b64_tr_b16 v[136:137], v0 offset:0
    ds_read_b64_tr_b16 v[138:139], v0 offset:1024
    s_waitcnt lgkmcnt(12)
    v_mfma_f32_32x32x16_bf16 v[40:55], v[144:147], v[96:99], v[40:55]
    v_add_u32 v1, 0xfffe4000, v1
    ds_read_b64_tr_b16 v[140:141], v1 offset:0
    ds_read_b64_tr_b16 v[142:143], v1 offset:1024
    s_waitcnt lgkmcnt(12)
    v_mfma_f32_32x32x16_bf16 v[56:71], v[148:151], v[96:99], v[56:71]
    v_add_u32 v2, 0xfffe4000, v2
    ds_read_b64_tr_b16 v[144:145], v2 offset:0
    ds_read_b64_tr_b16 v[146:147], v2 offset:1024
    s_waitcnt lgkmcnt(12)
    v_mfma_f32_32x32x16_bf16 v[8:23], v[152:155], v[100:103], v[8:23]
    v_add_u32 v3, 0xfffe4000, v3
    ds_read_b64_tr_b16 v[148:149], v3 offset:0
    ds_read_b64_tr_b16 v[150:151], v3 offset:1024
    s_waitcnt lgkmcnt(12)
    v_mfma_f32_32x32x16_bf16 v[24:39], v[156:159], v[100:103], v[24:39]
    ds_read_b64_tr_b16 v[152:153], v0 offset:4096
    ds_read_b64_tr_b16 v[154:155], v0 offset:5120
    s_waitcnt lgkmcnt(12)
    v_mfma_f32_32x32x16_bf16 v[40:55], v[160:163], v[100:103], v[40:55]
    ds_read_b64_tr_b16 v[156:157], v1 offset:4096
    ds_read_b64_tr_b16 v[158:159], v1 offset:5120
    s_waitcnt lgkmcnt(12)
    v_mfma_f32_32x32x16_bf16 v[56:71], v[164:167], v[100:103], v[56:71]
    ds_read_b64_tr_b16 v[160:161], v2 offset:4096
    ds_read_b64_tr_b16 v[162:163], v2 offset:5120
    s_waitcnt vmcnt(0)
    s_barrier
    s_cmp_lg_u32 s28, 4
    s_cbranch_scc1 sig_94
    s_lshl_b32 s42, s40, 11
    s_add_u32 s42, s42, 67108864
    s_lshl_b32 s43, s41, 7
    s_add_u32 s43, s43, s42
    v_mov_b32 v6, s43
    v_mov_b32 v104, 1
    s_mov_b64 exec, 1
    global_store_dword v6, v104, s[98:99] sc1
    s_mov_b64 exec, -1
    s_lshl_b32 s43, s54, 9
    s_add_u32 s42, s42, s43
    v_lshlrev_b32 v6, 7, v7
    v_add_u32 v6, s42, v6
    s_mov_b32 s57, 20000
    s_lshl_b32 s42, s40, 4
    v_mov_b32 v5, s42
reg_95:
    global_load_dword v104, v5, s[96:97] sc1
    s_sub_u32 s57, s57, 1
    s_waitcnt vmcnt(0)
    s_cbranch_scc1 sig_94
    v_cmp_gt_u32 vcc, 16, v104
    s_cbranch_vccz poll_96
    s_sleep 8
    s_branch reg_95
poll_96:
    s_mov_b64 exec, 0xf
    global_load_dword v104, v6, s[98:99] sc1
    s_sub_u32 s57, s57, 1
    s_waitcnt vmcnt(0)
    v_cmp_ne_u32 vcc, 1, v104
    s_mov_b64 exec, -1
    s_cbranch_scc1 sig_94
    s_cbranch_vccz sig_94
    s_sleep 2
    s_branch poll_96
sig_94:
    s_max_i32 s57, s57, 0
    s_barrier
    buffer_load_dwordx4 v[104:107], v4, s[24:27], s51 offen offset:0 sc1
    buffer_load_dwordx4 v[108:111], v4, s[24:27], s51 offen offset:1024 sc1
    buffer_load_dwordx4 v[112:115], v4, s[24:27], s51 offen offset:2048 sc1
    buffer_load_dwordx4 v[116:119], v4, s[24:27], s51 offen offset:3072 sc1
    s_waitcnt vmcnt(3) lgkmcnt(12)
    v_mfma_f32_32x32x16_bf16 v[8:23], v[136:139], v[104:107], v[8:23]
    ds_read_b64_tr_b16 v[164:165], v3 offset:4096
    ds_read_b64_tr_b16 v[166:167], v3 offset:5120
    s_add_u32 s51, s51, 4096
    buffer_load_dwordx4 v[120:123], v4, s[24:27], s51 offen offset:0 sc1
    s_waitcnt lgkmcnt(12)
    v_mfma_f32_32x32x16_bf16 v[24:39], v[140:143], v[104:107], v[24:39]
    v_add_u32 v0, 0x18000, v0
    ds_read_b64_tr_b16 v[136:137], v0 offset:0
    ds_read_b64_tr_b16 v[138:139], v0 offset:1024
    s_waitcnt lgkmcnt(12)
    v_mfma_f32_32x32x16_bf16 v[40:55], v[144:147], v[104:107], v[40:55]
    v_add_u32 v1, 0x18000, v1
    ds_read_b64_tr_b16 v[140:141], v1 offset:0
    ds_read_b64_tr_b16 v[142:143], v1 offset:1024
    buffer_load_dwordx4 v[124:127], v4, s[24:27], s51 offen offset:1024 sc1
    s_waitcnt lgkmcnt(12)
    v_mfma_f32_32x32x16_bf16 v[56:71], v[148:151], v[104:107], v[56:71]
    v_add_u32 v2, 0x18000, v2
    ds_read_b64_tr_b16 v[144:145], v2 offset:0
    ds_read_b64_tr_b16 v[146:147], v2 offset:1024
    s_waitcnt vmcnt(4) lgkmcnt(12)
    v_mfma_f32_32x32x16_bf16 v[8:23], v[152:155], v[108:111], v[8:23]
    v_add_u32 v3, 0x18000, v3
    ds_read_b64_tr_b16 v[148:149], v3 offset:0
    ds_read_b64_tr_b16 v[150:151], v3 offset:1024
    buffer_load_dwordx4 v[128:131], v4, s[24:27], s51 offen offset:2048 sc1
    s_waitcnt lgkmcnt(12)
    v_mfma_f32_32x32x16_bf16 v[24:39], v[156:159], v[108:111], v[24:39]
    ds_read_b64_tr_b16 v[152:153], v0 offset:4096
    ds_read_b64_tr_b16 v[154:155], v0 offset:5120
    s_cmp_ge_u32 s28, 4
    s_cbranch_scc1 ld_97
    s_add_u32 m0, s56, 83968
    s_add_u32 s36, s48, 0
    buffer_load_dwordx4 v5, s[8:11], s36 offen lds
    s_add_u32 m0, s56, 84992
    s_add_u32 s36, s48, 4096
    buffer_load_dwordx4 v5, s[8:11], s36 offen lds
ld_97:
    s_waitcnt lgkmcnt(12)
    v_mfma_f32_32x32x16_bf16 v[40:55], v[160:163], v[108:111], v[40:55]
    ds_read_b64_tr_b16 v[156:157], v1 offset:4096
    ds_read_b64_tr_b16 v[158:159], v1 offset:5120
    buffer_load_dwordx4 v[132:135], v4, s[24:27], s51 offen offset:3072 sc1
    s_waitcnt lgkmcnt(12)
    v_mfma_f32_32x32x16_bf16 v[56:71], v[164:167], v[108:111], v[56:71]
    ds_read_b64_tr_b16 v[160:161], v2 offset:4096
    ds_read_b64_tr_b16 v[162:163], v2 offset:5120
    s_cmp_ge_u32 s28, 4
    s_cbranch_scc1 ld_98
    s_add_u32 m0, s56, 92160
    s_add_u32 s36, s48, 131072
    buffer_load_dwordx4 v5, s[8:11], s36 offen lds
    s_add_u32 m0, s56, 93184
    s_add_u32 s36, s48, 135168
    buffer_load_dwordx4 v5, s[8:11], s36 offen lds
ld_98:
    s_waitcnt vmcnt(5) lgkmcnt(12)
    v_mfma_f32_32x32x16_bf16 v[8:23], v[136:139], v[112:115], v[8:23]
    ds_read_b64_tr_b16 v[164:165], v3 offset:4096
    ds_read_b64_tr_b16 v[166:167], v3 offset:5120
    buffer_load_dwordx4 v[72:75], v4, s[24:27], s52 offen offset:0 sc1
    s_waitcnt lgkmcnt(12)
    v_mfma_f32_32x32x16_bf16 v[24:39], v[140:143], v[112:115], v[24:39]
    v_add_u32 v0, 0xfffec000, v0
    ds_read_b64_tr_b16 v[136:137], v0 offset:0
    ds_read_b64_tr_b16 v[138:139], v0 offset:1024
    s_waitcnt lgkmcnt(12)
    v_mfma_f32_32x32x16_bf16 v[40:55], v[144:147], v[112:115], v[40:55]
    v_add_u32 v1, 0xfffec000, v1
    ds_read_b64_tr_b16 v[140:141], v1 offset:0
    ds_read_b64_tr_b16 v[142:143], v1 offset:1024
    buffer_load_dwordx4 v[76:79], v4, s[24:27], s52 offen offset:1024 sc1
    s_waitcnt lgkmcnt(12)
    v_mfma_f32_32x32x16_bf16 v[56:71], v[148:151], v[112:115], v[56:71]
    v_add_u32 v2, 0xfffec000, v2
    ds_read_b64_tr_b16 v[144:145], v2 offset:0
    ds_read_b64_tr_b16 v[146:147], v2 offset:1024
    s_cmp_ge_u32 s28, 4
    s_cbranch_scc1 ld_99
    s_add_u32 m0, s56, 67584
    s_add_u32 s36, s48, 32768
    buffer_load_dwordx4 v5, s[8:11], s36 offen lds
    s_add_u32 m0, s56, 68608
    s_add_u32 s36, s48, 36864
    buffer_load_dwordx4 v5, s[8:11], s36 offen lds
ld_99:
    s_waitcnt vmcnt(6) lgkmcnt(12)
    v_mfma_f32_32x32x16_bf16 v[8:23], v[152:155], v[116:119], v[8:23]
    v_add_u32 v3, 0xfffec000, v3
    ds_read_b64_tr_b16 v[148:149], v3 offset:0
    ds_read_b64_tr_b16 v[150:151], v3 offset:1024
    buffer_load_dwordx4 v[80:83], v4, s[24:27], s52 offen offset:2048 sc1
    s_waitcnt lgkmcnt(12)
    v_mfma_f32_32x32x16_bf16 v[24:39], v[156:159], v[116:119], v[24:39]
    ds_read_b64_tr_b16 v[152:153], v0 offset:4096
    ds_read_b64_tr_b16 v[154:155], v0 offset:5120
    s_cmp_ge_u32 s28, 4
    s_cbranch_scc1 ld_100
    s_add_u32 m0, s56, 75776
    s_add_u32 s36, s48, 163840
    buffer_load_dwordx4 v5, s[8:11], s36 offen lds
    s_add_u32 m0, s56, 76800
    s_add_u32 s36, s48, 167936
    buffer_load_dwordx4 v5, s[8:11], s36 offen lds
ld_100:
    s_waitcnt lgkmcnt(12)
    v_mfma_f32_32x32x16_bf16 v[40:55], v[160:163], v[116:119], v[40:55]
    ds_read_b64_tr_b16 v[156:157], v1 offset:4096
    ds_read_b64_tr_b16 v[158:159], v1 offset:5120
    s_waitcnt lgkmcnt(12)
    v_mfma_f32_32x32x16_bf16 v[56:71], v[164:167], v[116:119], v[56:71]
    ds_read_b64_tr_b16 v[160:161], v2 offset:4096
    ds_read_b64_tr_b16 v[162:163], v2 offset:5120
    s_waitcnt vmcnt(6) lgkmcnt(12)
    v_mfma_f32_32x32x16_bf16 v[8:23], v[136:139], v[120:123], v[8:23]
    ds_read_b64_tr_b16 v[164:165], v3 offset:4096
    ds_read_b64_tr_b16 v[166:167], v3 offset:5120
    buffer_load_dwordx4 v[84:87], v4, s[24:27], s52 offen offset:3072 sc1
    s_waitcnt lgkmcnt(12)
    v_mfma_f32_32x32x16_bf16 v[24:39], v[140:143], v[120:123], v[24:39]
    v_add_u32 v0, 0x10000, v0
    ds_read_b64_tr_b16 v[136:137], v0 offset:0
    ds_read_b64_tr_b16 v[138:139], v0 offset:1024
    s_cmp_ge_u32 s28, 4
    s_cbranch_scc1 ld_101
    s_add_u32 m0, s56, 0
    s_add_u32 s36, s48, 65536
    buffer_load_dwordx4 v5, s[8:11], s36 offen lds
    s_add_u32 m0, s56, 1024
    s_add_u32 s36, s48, 69632
    buffer_load_dwordx4 v5, s[8:11], s36 offen lds
ld_101:
    s_waitcnt lgkmcnt(12)
    v_mfma_f32_32x32x16_bf16 v[40:55], v[144:147], v[120:123], v[40:55]
    v_add_u32 v1, 0x10000, v1
    ds_read_b64_tr_b16 v[140:141], v1 offset:0
    ds_read_b64_tr_b16 v[142:143], v1 offset:1024
    s_waitcnt lgkmcnt(12)
    v_mfma_f32_32x32x16_bf16 v[56:71], v[148:151], v[120:123], v[56:71]
    v_add_u32 v2, 0x10000, v2
    ds_read_b64_tr_b16 v[144:145], v2 offset:0
    ds_read_b64_tr_b16 v[146:147], v2 offset:1024
    s_cmp_ge_u32 s28, 4
    s_cbranch_scc1 ld_102
    s_add_u32 m0, s56, 8192
    s_add_u32 s36, s48, 196608
    buffer_load_dwordx4 v5, s[8:11], s36 offen lds
    s_add_u32 m0, s56, 9216
    s_add_u32 s36, s48, 200704
    buffer_load_dwordx4 v5, s[8:11], s36 offen lds
ld_102:
    s_waitcnt vmcnt(6) lgkmcnt(12)
    v_mfma_f32_32x32x16_bf16 v[8:23], v[152:155], v[124:127], v[8:23]
    v_add_u32 v3, 0x10000, v3
    ds_read_b64_tr_b16 v[148:149], v3 offset:0
    ds_read_b64_tr_b16 v[150:151], v3 offset:1024
    s_add_u32 s52, s52, 4096
    buffer_load_dwordx4 v[88:91], v4, s[24:27], s52 offen offset:0 sc1
    s_waitcnt lgkmcnt(12)
    v_mfma_f32_32x32x16_bf16 v[24:39], v[156:159], v[124:127], v[24:39]
    ds_read_b64_tr_b16 v[152:153], v0 offset:4096
    ds_read_b64_tr_b16 v[154:155], v0 offset:5120
    s_waitcnt lgkmcnt(12)
    v_mfma_f32_32x32x16_bf16 v[40:55], v[160:163], v[124:127], v[40:55]
    ds_read_b64_tr_b16 v[156:157], v1 offset:4096
    ds_read_b64_tr_b16 v[158:159], v1 offset:5120
    s_waitcnt lgkmcnt(12)
    v_mfma_f32_32x32x16_bf16 v[56:71], v[164:167], v[124:127], v[56:71]
    ds_read_b64_tr_b16 v[160:161], v2 offset:4096
    ds_read_b64_tr_b16 v[162:163], v2 offset:5120
    s_cmp_ge_u32 s28, 4
    s_cbranch_scc1 ld_103
    s_add_u32 m0, s56, 16384
    s_add_u32 s36, s48, 98304
    buffer_load_dwordx4 v5, s[8:11], s36 offen lds
    s_add_u32 m0, s56, 17408
    s_add_u32 s36, s48, 102400
    buffer_load_dwordx4 v5, s[8:11], s36 offen lds
ld_103:
    s_cmp_ge_u32 s28, 4
    s_cbranch_scc1 ld_104
    s_waitcnt vmcnt(15)
ld_104:
    s_barrier
    s_waitcnt vmcnt(6) lgkmcnt(12)
    v_mfma_f32_32x32x16_bf16 v[8:23], v[136:139], v[128:131], v[8:23]
    ds_read_b64_tr_b16 v[164:165], v3 offset:4096
    ds_read_b64_tr_b16 v[166:167], v3 offset:5120
    buffer_load_dwordx4 v[92:95], v4, s[24:27], s52 offen offset:1024 sc1
    s_waitcnt lgkmcnt(12)
    v_mfma_f32_32x32x16_bf16 v[24:39], v[140:143], v[128:131], v[24:39]
    v_add_u32 v0, 0xffff8800, v0
    ds_read_b64_tr_b16 v[136:137], v0 offset:0
    ds_read_b64_tr_b16 v[138:139], v0 offset:1024
    s_cmp_ge_u32 s28, 4
    s_cbranch_scc1 ld_105
    s_add_u32 m0, s56, 24576
    s_add_u32 s36, s48, 229376
    buffer_load_dwordx4 v5, s[8:11], s36 offen lds
    s_add_u32 m0, s56, 25600
    s_add_u32 s36, s48, 233472
    buffer_load_dwordx4 v5, s[8:11], s36 offen lds
ld_105:
    s_waitcnt lgkmcnt(12)
    v_mfma_f32_32x32x16_bf16 v[40:55], v[144:147], v[128:131], v[40:55]
    v_add_u32 v1, 0xffff8800, v1
    ds_read_b64_tr_b16 v[140:141], v1 offset:0
    ds_read_b64_tr_b16 v[142:143], v1 offset:1024
    s_waitcnt lgkmcnt(12)
    v_mfma_f32_32x32x16_bf16 v[56:71], v[148:151], v[128:131], v[56:71]
    v_add_u32 v2, 0xffff8800, v2
    ds_read_b64_tr_b16 v[144:145], v2 offset:0
    ds_read_b64_tr_b16 v[146:147], v2 offset:1024
    s_waitcnt vmcnt(6) lgkmcnt(12)
    v_mfma_f32_32x32x16_bf16 v[8:23], v[152:155], v[132:135], v[8:23]
    v_add_u32 v3, 0xffff8800, v3
    ds_read_b64_tr_b16 v[148:149], v3 offset:0
    ds_read_b64_tr_b16 v[150:151], v3 offset:1024
    buffer_load_dwordx4 v[96:99], v4, s[24:27], s52 offen offset:2048 sc1
    s_waitcnt lgkmcnt(12)
    v_mfma_f32_32x32x16_bf16 v[24:39], v[156:159], v[132:135], v[24:39]
    ds_read_b64_tr_b16 v[152:153], v0 offset:4096
    ds_read_b64_tr_b16 v[154:155], v0 offset:5120
    s_cmp_ge_u32 s28, 4
    s_cbranch_scc1 ld_106
    s_add_u32 m0, s56, 147456
    s_add_u32 s36, s49, 0
    buffer_load_dwordx4 v5, s[8:11], s36 offen lds
    s_add_u32 m0, s56, 148480
    s_add_u32 s36, s49, 4096
    buffer_load_dwordx4 v5, s[8:11], s36 offen lds
ld_106:
    s_waitcnt lgkmcnt(12)
    v_mfma_f32_32x32x16_bf16 v[40:55], v[160:163], v[132:135], v[40:55]
    ds_read_b64_tr_b16 v[156:157], v1 offset:4096
    ds_read_b64_tr_b16 v[158:159], v1 offset:5120
    s_waitcnt lgkmcnt(12)
    v_mfma_f32_32x32x16_bf16 v[56:71], v[164:167], v[132:135], v[56:71]
    ds_read_b64_tr_b16 v[160:161], v2 offset:4096
    ds_read_b64_tr_b16 v[162:163], v2 offset:5120
    s_cmp_ge_u32 s28, 4
    s_cbranch_scc1 ld_107
    s_add_u32 m0, s56, 155648
    s_add_u32 s36, s49, 131072
    buffer_load_dwordx4 v5, s[8:11], s36 offen lds
    s_add_u32 m0, s56, 156672
    s_add_u32 s36, s49, 135168
    buffer_load_dwordx4 v5, s[8:11], s36 offen lds
ld_107:
    s_cmp_ge_u32 s28, 4
    s_cbranch_scc1 ld_108
    s_waitcnt vmcnt(16)
ld_108:
    s_barrier
    s_waitcnt vmcnt(6) lgkmcnt(12)
    v_mfma_f32_32x32x16_bf16 v[8:23], v[136:139], v[72:75], v[8:23]
    ds_read_b64_tr_b16 v[164:165], v3 offset:4096
    ds_read_b64_tr_b16 v[166:167], v3 offset:5120
    buffer_load_dwordx4 v[100:103], v4, s[24:27], s52 offen offset:3072 sc1
    s_waitcnt lgkmcnt(12)
    v_mfma_f32_32x32x16_bf16 v[24:39], v[140:143], v[72:75], v[24:39]
    v_add_u32 v0, 0xffffc000, v0
    ds_read_b64_tr_b16 v[136:137], v0 offset:0
    ds_read_b64_tr_b16 v[138:139], v0 offset:1024
    s_waitcnt lgkmcnt(12)
    v_mfma_f32_32x32x16_bf16 v[40:55], v[144:147], v[72:75], v[40:55]
    v_add_u32 v1, 0xffffc000, v1
    ds_read_b64_tr_b16 v[140:141], v1 offset:0
    ds_read_b64_tr_b16 v[142:143], v1 offset:1024
    s_waitcnt lgkmcnt(12)
    v_mfma_f32_32x32x16_bf16 v[56:71], v[148:151], v[72:75], v[56:71]
    v_add_u32 v2, 0xffffc000, v2
    ds_read_b64_tr_b16 v[144:145], v2 offset:0
    ds_read_b64_tr_b16 v[146:147], v2 offset:1024
    s_cmp_ge_u32 s28, 4
    s_cbranch_scc1 ld_109
    s_add_u32 m0, s56, 32768
    s_add_u32 s36, s49, 32768
    buffer_load_dwordx4 v5, s[8:11], s36 offen lds
    s_add_u32 m0, s56, 33792
    s_add_u32 s36, s49, 36864
    buffer_load_dwordx4 v5, s[8:11], s36 offen lds
ld_109:
    s_waitcnt vmcnt(6) lgkmcnt(12)
    v_mfma_f32_32x32x16_bf16 v[8:23], v[152:155], v[76:79], v[8:23]
    v_add_u32 v3, 0xffffc000, v3
    ds_read_b64_tr_b16 v[148:149], v3 offset:0
    ds_read_b64_tr_b16 v[150:151], v3 offset:1024
    buffer_load_dwordx4 v[104:107], v4, s[24:27], s53 offen offset:0 sc1
    s_waitcnt lgkmcnt(12)
    v_mfma_f32_32x32x16_bf16 v[24:39], v[156:159], v[76:79], v[24:39]
    ds_read_b64_tr_b16 v[152:153], v0 offset:4096
    ds_read_b64_tr_b16 v[154:155], v0 offset:5120
    s_cmp_ge_u32 s28, 4
    s_cbranch_scc1 ld_110
    s_add_u32 m0, s56, 40960
    s_add_u32 s36, s49, 163840
    buffer_load_dwordx4 v5, s[8:11], s36 offen lds
    s_add_u32 m0, s56, 41984
    s_add_u32 s36, s49, 167936
    buffer_load_dwordx4 v5, s[8:11], s36 offen lds
ld_110:
    s_waitcnt lgkmcnt(12)
    v_mfma_f32_32x32x16_bf16 v[40:55], v[160:163], v[76:79], v[40:55]
    ds_read_b64_tr_b16 v[156:157], v1 offset:4096
    ds_read_b64_tr_b16 v[158:159], v1 offset:5120
    s_waitcnt lgkmcnt(12)
    v_mfma_f32_32x32x16_bf16 v[56:71], v[164:167], v[76:79], v[56:71]
    ds_read_b64_tr_b16 v[160:161], v2 offset:4096
    ds_read_b64_tr_b16 v[162:163], v2 offset:5120
    s_cmp_ge_u32 s28, 4
    s_cbranch_scc1 ld_111
    s_waitcnt vmcnt(17)
ld_111:
    s_barrier
    s_waitcnt vmcnt(6) lgkmcnt(12)
    v_mfma_f32_32x32x16_bf16 v[8:23], v[136:139], v[80:83], v[8:23]
    ds_read_b64_tr_b16 v[164:165], v3 offset:4096
    ds_read_b64_tr_b16 v[166:167], v3 offset:5120
    buffer_load_dwordx4 v[108:111], v4, s[24:27], s53 offen offset:1024 sc1
    s_waitcnt lgkmcnt(12)
    v_mfma_f32_32x32x16_bf16 v[24:39], v[140:143], v[80:83], v[24:39]
    v_add_u32 v0, 0xfffef800, v0
    ds_read_b64_tr_b16 v[136:137], v0 offset:0
    ds_read_b64_tr_b16 v[138:139], v0 offset:1024
    s_cmp_ge_u32 s28, 4
    s_cbranch_scc1 ld_112
    s_add_u32 m0, s56, 131072
    s_add_u32 s36, s49, 65536
    buffer_load_dwordx4 v5, s[8:11], s36 offen lds
    s_add_u32 m0, s56, 132096
    s_add_u32 s36, s49, 69632
    buffer_load_dwordx4 v5, s[8:11], s36 offen lds
ld_112:
    s_waitcnt lgkmcnt(12)
    v_mfma_f32_32x32x16_bf16 v[40:55], v[144:147], v[80:83], v[40:55]
    v_add_u32 v1, 0xfffef800, v1
    ds_read_b64_tr_b16 v[140:141], v1 offset:0
    ds_read_b64_tr_b16 v[142:143], v1 offset:1024
    s_waitcnt lgkmcnt(12)
    v_mfma_f32_32x32x16_bf16 v[56:71], v[148:151], v[80:83], v[56:71]
    v_add_u32 v2, 0xfffef800, v2
    ds_read_b64_tr_b16 v[144:145], v2 offset:0
    ds_read_b64_tr_b16 v[146:147], v2 offset:1024
    s_cmp_ge_u32 s28, 4
    s_cbranch_scc1 ld_113
    s_add_u32 m0, s56, 139264
    s_add_u32 s36, s49, 196608
    buffer_load_dwordx4 v5, s[8:11], s36 offen lds
    s_add_u32 m0, s56, 140288
    s_add_u32 s36, s49, 200704
    buffer_load_dwordx4 v5, s[8:11], s36 offen lds
ld_113:
    s_waitcnt vmcnt(6) lgkmcnt(12)
    v_mfma_f32_32x32x16_bf16 v[8:23], v[152:155], v[84:87], v[8:23]
    v_add_u32 v3, 0xfffef800, v3
    ds_read_b64_tr_b16 v[148:149], v3 offset:0
    ds_read_b64_tr_b16 v[150:151], v3 offset:1024
    buffer_load_dwordx4 v[112:115], v4, s[24:27], s53 offen offset:2048 sc1
    s_waitcnt lgkmcnt(12)
    v_mfma_f32_32x32x16_bf16 v[24:39], v[156:159], v[84:87], v[24:39]
    ds_read_b64_tr_b16 v[152:153], v0 offset:4096
    ds_read_b64_tr_b16 v[154:155], v0 offset:5120
    s_waitcnt lgkmcnt(12)
    v_mfma_f32_32x32x16_bf16 v[40:55], v[160:163], v[84:87], v[40:55]
    ds_read_b64_tr_b16 v[156:157], v1 offset:4096
    ds_read_b64_tr_b16 v[158:159], v1 offset:5120
    s_waitcnt lgkmcnt(12)
    v_mfma_f32_32x32x16_bf16 v[56:71], v[164:167], v[84:87], v[56:71]
    ds_read_b64_tr_b16 v[160:161], v2 offset:4096
    ds_read_b64_tr_b16 v[162:163], v2 offset:5120
    s_cmp_ge_u32 s28, 4
    s_cbranch_scc1 ld_114
    s_add_u32 m0, s56, 49152
    s_add_u32 s36, s49, 98304
    buffer_load_dwordx4 v5, s[8:11], s36 offen lds
    s_add_u32 m0, s56, 50176
    s_add_u32 s36, s49, 102400
    buffer_load_dwordx4 v5, s[8:11], s36 offen lds
ld_114:
    s_cmp_ge_u32 s28, 4
    s_cbranch_scc1 ld_115
    s_waitcnt vmcnt(19)
ld_115:
    s_barrier
    s_waitcnt vmcnt(6) lgkmcnt(12)
    v_mfma_f32_32x32x16_bf16 v[8:23], v[136:139], v[88:91], v[8:23]
    ds_read_b64_tr_b16 v[164:165], v3 offset:4096
    ds_read_b64_tr_b16 v[166:167], v3 offset:5120
    buffer_load_dwordx4 v[116:119], v4, s[24:27], s53 offen offset:3072 sc1
    s_waitcnt lgkmcnt(12)
    v_mfma_f32_32x32x16_bf16 v[24:39], v[140:143], v[88:91], v[24:39]
    v_add_u32 v0, 0x4000, v0
    ds_read_b64_tr_b16 v[136:137], v0 offset:0
    ds_read_b64_tr_b16 v[138:139], v0 offset:1024
    s_cmp_ge_u32 s28, 4
    s_cbranch_scc1 ld_116
    s_add_u32 m0, s56, 57344
    s_add_u32 s36, s49, 229376
    buffer_load_dwordx4 v5, s[8:11], s36 offen lds
    s_add_u32 m0, s56, 58368
    s_add_u32 s36, s49, 233472
    buffer_load_dwordx4 v5, s[8:11], s36 offen lds
ld_116:
    s_waitcnt lgkmcnt(12)
    v_mfma_f32_32x32x16_bf16 v[40:55], v[144:147], v[88:91], v[40:55]
    v_add_u32 v1, 0x4000, v1
    ds_read_b64_tr_b16 v[140:141], v1 offset:0
    ds_read_b64_tr_b16 v[142:143], v1 offset:1024
    s_waitcnt lgkmcnt(12)
    v_mfma_f32_32x32x16_bf16 v[56:71], v[148:151], v[88:91], v[56:71]
    v_add_u32 v2, 0x4000, v2
    ds_read_b64_tr_b16 v[144:145], v2 offset:0
    ds_read_b64_tr_b16 v[146:147], v2 offset:1024
    s_waitcnt vmcnt(6) lgkmcnt(12)
    v_mfma_f32_32x32x16_bf16 v[8:23], v[152:155], v[92:95], v[8:23]
    v_add_u32 v3, 0x4000, v3
    ds_read_b64_tr_b16 v[148:149], v3 offset:0
    ds_read_b64_tr_b16 v[150:151], v3 offset:1024
    s_add_u32 s53, s53, 4096
    buffer_load_dwordx4 v[120:123], v4, s[24:27], s53 offen offset:0 sc1
    s_waitcnt lgkmcnt(12)
    v_mfma_f32_32x32x16_bf16 v[24:39], v[156:159], v[92:95], v[24:39]
    ds_read_b64_tr_b16 v[152:153], v0 offset:4096
    ds_read_b64_tr_b16 v[154:155], v0 offset:5120
    s_waitcnt lgkmcnt(12)
    v_mfma_f32_32x32x16_bf16 v[40:55], v[160:163], v[92:95], v[40:55]
    ds_read_b64_tr_b16 v[156:157], v1 offset:4096
    ds_read_b64_tr_b16 v[158:159], v1 offset:5120
    s_waitcnt lgkmcnt(12)
    v_mfma_f32_32x32x16_bf16 v[56:71], v[164:167], v[92:95], v[56:71]
    ds_read_b64_tr_b16 v[160:161], v2 offset:4096
    ds_read_b64_tr_b16 v[162:163], v2 offset:5120
    s_cmp_ge_u32 s28, 4
    s_cbranch_scc1 ld_117
    s_waitcnt vmcnt(12)
ld_117:
    s_barrier
    s_waitcnt vmcnt(6) lgkmcnt(12)
    v_mfma_f32_32x32x16_bf16 v[8:23], v[136:139], v[96:99], v[8:23]
    ds_read_b64_tr_b16 v[164:165], v3 offset:4096
    ds_read_b64_tr_b16 v[166:167], v3 offset:5120
    buffer_load_dwordx4 v[124:127], v4, s[24:27], s53 offen offset:1024 sc1
    s_waitcnt lgkmcnt(12)
    v_mfma_f32_32x32x16_bf16 v[24:39], v[140:143], v[96:99], v[24:39]
    v_add_u32 v2, 0x20000, v2
    ds_read_b64_tr_b16 v[136:137], v2 offset:0
    ds_read_b64_tr_b16 v[138:139], v2 offset:1024
    s_waitcnt lgkmcnt(12)
    v_mfma_f32_32x32x16_bf16 v[40:55], v[144:147], v[96:99], v[40:55]
    v_add_u32 v3, 0x20000, v3
    ds_read_b64_tr_b16 v[140:141], v3 offset:0
    ds_read_b64_tr_b16 v[142:143], v3 offset:1024
    s_waitcnt lgkmcnt(12)
    v_mfma_f32_32x32x16_bf16 v[56:71], v[148:151], v[96:99], v[56:71]
    ds_read_b64_tr_b16 v[144:145], v2 offset:4096
    ds_read_b64_tr_b16 v[146:147], v2 offset:5120
    s_waitcnt vmcnt(6) lgkmcnt(12)
    v_mfma_f32_32x32x16_bf16 v[8:23], v[152:155], v[100:103], v[8:23]
    ds_read_b64_tr_b16 v[148:149], v3 offset:4096
    ds_read_b64_tr_b16 v[150:151], v3 offset:5120
    buffer_load_dwordx4 v[128:131], v4, s[24:27], s53 offen offset:2048 sc1
    s_waitcnt lgkmcnt(12)
    v_mfma_f32_32x32x16_bf16 v[24:39], v[156:159], v[100:103], v[24:39]
    v_add_u32 v2, 0xfffe4000, v2
    ds_read_b64_tr_b16 v[152:153], v2 offset:0
    ds_read_b64_tr_b16 v[154:155], v2 offset:1024
    s_waitcnt lgkmcnt(12)
    v_mfma_f32_32x32x16_bf16 v[40:55], v[160:163], v[100:103], v[40:55]
    v_add_u32 v3, 0xfffe4000, v3
    ds_read_b64_tr_b16 v[156:157], v3 offset:0
    ds_read_b64_tr_b16 v[158:159], v3 offset:1024
    s_waitcnt lgkmcnt(12)
    v_mfma_f32_32x32x16_bf16 v[56:71], v[164:167], v[100:103], v[56:71]
    ds_read_b64_tr_b16 v[160:161], v2 offset:4096
    ds_read_b64_tr_b16 v[162:163], v2 offset:5120
    s_cmp_ge_u32 s28, 4
    s_cbranch_scc1 ld_118
    s_waitcnt vmcnt(3)
ld_118:
    s_barrier
    s_waitcnt vmcnt(6) lgkmcnt(12)
    v_mfma_f32_32x32x16_bf16 v[40:55], v[136:139], v[104:107], v[40:55]
    ds_read_b64_tr_b16 v[164:165], v3 offset:4096
    ds_read_b64_tr_b16 v[166:167], v3 offset:5120
    buffer_load_dwordx4 v[132:135], v4, s[24:27], s53 offen offset:3072 sc1
    s_waitcnt lgkmcnt(12)
    v_mfma_f32_32x32x16_bf16 v[56:71], v[140:143], v[104:107], v[56:71]
    v_add_u32 v2, 0x18000, v2
    ds_read_b64_tr_b16 v[136:137], v2 offset:0
    ds_read_b64_tr_b16 v[138:139], v2 offset:1024
    s_waitcnt vmcnt(6) lgkmcnt(12)
    v_mfma_f32_32x32x16_bf16 v[40:55], v[144:147], v[108:111], v[40:55]
    v_add_u32 v3, 0x18000, v3
    ds_read_b64_tr_b16 v[140:141], v3 offset:0
    ds_read_b64_tr_b16 v[142:143], v3 offset:1024
    s_waitcnt lgkmcnt(12)
    v_mfma_f32_32x32x16_bf16 v[56:71], v[148:151], v[108:111], v[56:71]
    ds_read_b64_tr_b16 v[144:145], v2 offset:4096
    ds_read_b64_tr_b16 v[146:147], v2 offset:5120
    s_waitcnt vmcnt(5) lgkmcnt(12)
    v_mfma_f32_32x32x16_bf16 v[40:55], v[152:155], v[112:115], v[40:55]
    ds_read_b64_tr_b16 v[148:149], v3 offset:4096
    ds_read_b64_tr_b16 v[150:151], v3 offset:5120
    s_waitcnt lgkmcnt(12)
    v_mfma_f32_32x32x16_bf16 v[56:71], v[156:159], v[112:115], v[56:71]
    v_add_u32 v2, 0xfffec000, v2
    ds_read_b64_tr_b16 v[152:153], v2 offset:0
    ds_read_b64_tr_b16 v[154:155], v2 offset:1024
    s_waitcnt vmcnt(4) lgkmcnt(12)
    v_mfma_f32_32x32x16_bf16 v[40:55], v[160:163], v[116:119], v[40:55]
    v_add_u32 v3, 0xfffec000, v3
    ds_read_b64_tr_b16 v[156:157], v3 offset:0
    ds_read_b64_tr_b16 v[158:159], v3 offset:1024
    s_waitcnt lgkmcnt(12)
    v_mfma_f32_32x32x16_bf16 v[56:71], v[164:167], v[116:119], v[56:71]
    ds_read_b64_tr_b16 v[160:161], v2 offset:4096
    ds_read_b64_tr_b16 v[162:163], v2 offset:5120
    s_barrier
    s_cmp_ge_u32 s28, 4
    s_cselect_b32 s42, 4, 0
    s_add_u32 s42, s42, s28
    s_lshl_b32 s42, s42, 13
    v_add_u32 v5, s42, v4
    s_mul_i32 s43, s29, -12
    s_add_u32 s43, s43, 6
    s_add_u32 s43, s43, s28
    s_cmp_ge_u32 s43, 4
    s_cselect_b32 s42, 4, 0
    s_add_u32 s42, s42, s43
    s_lshl_b32 s42, s42, 13
    v_add_u32 v6, s42, v4
    s_waitcnt vmcnt(3) lgkmcnt(12)
    v_mfma_f32_32x32x16_bf16 v[40:55], v[136:139], v[120:123], v[40:55]
    ds_read_b64_tr_b16 v[164:165], v3 offset:4096
    ds_read_b64_tr_b16 v[166:167], v3 offset:5120
    s_waitcnt lgkmcnt(12)
    v_mfma_f32_32x32x16_bf16 v[56:71], v[140:143], v[120:123], v[56:71]
    v_add_u32 v0, 0x20000, v0
    ds_read_b64_tr_b16 v[136:137], v0 offset:0
    ds_read_b64_tr_b16 v[138:139], v0 offset:1024
    s_waitcnt vmcnt(2) lgkmcnt(12)
    v_mfma_f32_32x32x16_bf16 v[40:55], v[144:147], v[124:127], v[40:55]
    v_add_u32 v1, 0x20000, v1
    ds_read_b64_tr_b16 v[140:141], v1 offset:0
    ds_read_b64_tr_b16 v[142:143], v1 offset:1024
    s_waitcnt lgkmcnt(12)
    v_mfma_f32_32x32x16_bf16 v[56:71], v[148:151], v[124:127], v[56:71]
    ds_read_b64_tr_b16 v[144:145], v0 offset:4096
    ds_read_b64_tr_b16 v[146:147], v0 offset:5120
    s_waitcnt vmcnt(1) lgkmcnt(12)
    v_mfma_f32_32x32x16_bf16 v[40:55], v[152:155], v[128:131], v[40:55]
    ds_read_b64_tr_b16 v[148:149], v1 offset:4096
    ds_read_b64_tr_b16 v[150:151], v1 offset:5120
    s_waitcnt lgkmcnt(12)
    v_mfma_f32_32x32x16_bf16 v[56:71], v[156:159], v[128:131], v[56:71]
    v_add_u32 v0, 0xfffe4000, v0
    ds_read_b64_tr_b16 v[152:153], v0 offset:0
    ds_read_b64_tr_b16 v[154:155], v0 offset:1024
    s_waitcnt vmcnt(0) lgkmcnt(12)
    v_mfma_f32_32x32x16_bf16 v[40:55], v[160:163], v[132:135], v[40:55]
    v_add_u32 v1, 0xfffe4000, v1
    ds_read_b64_tr_b16 v[156:157], v1 offset:0
    ds_read_b64_tr_b16 v[158:159], v1 offset:1024
    s_waitcnt lgkmcnt(12)
    v_mfma_f32_32x32x16_bf16 v[56:71], v[164:167], v[132:135], v[56:71]
    ds_read_b64_tr_b16 v[160:161], v0 offset:4096
    ds_read_b64_tr_b16 v[162:163], v0 offset:5120
    s_waitcnt lgkmcnt(12)
    v_mfma_f32_32x32x16_bf16 v[8:23], v[136:139], v[104:107], v[8:23]
    ds_read_b64_tr_b16 v[164:165], v1 offset:4096
    ds_read_b64_tr_b16 v[166:167], v1 offset:5120
    s_waitcnt lgkmcnt(12)
    v_mfma_f32_32x32x16_bf16 v[24:39], v[140:143], v[104:107], v[24:39]
    v_add_u32 v0, 0x18000, v0
    ds_read_b64_tr_b16 v[136:137], v0 offset:0
    ds_read_b64_tr_b16 v[138:139], v0 offset:1024
    s_waitcnt lgkmcnt(12)
    v_mfma_f32_32x32x16_bf16 v[8:23], v[144:147], v[108:111], v[8:23]
    v_add_u32 v1, 0x18000, v1
    ds_read_b64_tr_b16 v[140:141], v1 offset:0
    ds_read_b64_tr_b16 v[142:143], v1 offset:1024
    s_waitcnt lgkmcnt(12)
    v_mfma_f32_32x32x16_bf16 v[24:39], v[148:151], v[108:111], v[24:39]
    ds_read_b64_tr_b16 v[144:145], v0 offset:4096
    ds_read_b64_tr_b16 v[146:147], v0 offset:5120
    s_waitcnt lgkmcnt(12)
    v_mfma_f32_32x32x16_bf16 v[8:23], v[152:155], v[112:115], v[8:23]
    ds_read_b64_tr_b16 v[148:149], v1 offset:4096
    ds_read_b64_tr_b16 v[150:151], v1 offset:5120
    ds_write_b128 v5, v[40:43] offset:0
    ds_write_b128 v5, v[44:47] offset:1024
    s_waitcnt lgkmcnt(14)
    v_mfma_f32_32x32x16_bf16 v[24:39], v[156:159], v[112:115], v[24:39]
    v_add_u32 v0, 0xfffec000, v0
    ds_read_b64_tr_b16 v[152:153], v0 offset:0
    ds_read_b64_tr_b16 v[154:155], v0 offset:1024
    s_waitcnt lgkmcnt(14)
    v_mfma_f32_32x32x16_bf16 v[8:23], v[160:163], v[116:119], v[8:23]
    v_add_u32 v1, 0xfffec000, v1
    ds_read_b64_tr_b16 v[156:157], v1 offset:0
    ds_read_b64_tr_b16 v[158:159], v1 offset:1024
    ds_write_b128 v5, v[48:51] offset:2048
    ds_write_b128 v5, v[52:55] offset:3072
    s_waitcnt lgkmcnt(15)
    v_mfma_f32_32x32x16_bf16 v[24:39], v[164:167], v[116:119], v[24:39]
    ds_read_b64_tr_b16 v[160:161], v0 offset:4096
    ds_read_b64_tr_b16 v[162:163], v0 offset:5120
    s_waitcnt lgkmcnt(15)
    v_mfma_f32_32x32x16_bf16 v[8:23], v[136:139], v[120:123], v[8:23]
    ds_read_b64_tr_b16 v[164:165], v1 offset:4096
    ds_read_b64_tr_b16 v[166:167], v1 offset:5120
    ds_write_b128 v5, v[56:59] offset:4096
    ds_write_b128 v5, v[60:63] offset:5120
    s_waitcnt lgkmcnt(15)
    v_mfma_f32_32x32x16_bf16 v[24:39], v[140:143], v[120:123], v[24:39]
    s_waitcnt lgkmcnt(15)
    v_mfma_f32_32x32x16_bf16 v[8:23], v[144:147], v[124:127], v[8:23]
    ds_write_b128 v5, v[64:67] offset:6144
    ds_write_b128 v5, v[68:71] offset:7168
    s_waitcnt lgkmcnt(15)
    v_mfma_f32_32x32x16_bf16 v[24:39], v[148:151], v[124:127], v[24:39]
    s_waitcnt lgkmcnt(12)
    v_mfma_f32_32x32x16_bf16 v[8:23], v[152:155], v[128:131], v[8:23]
    s_waitcnt lgkmcnt(10)
    v_mfma_f32_32x32x16_bf16 v[24:39], v[156:159], v[128:131], v[24:39]
    s_waitcnt lgkmcnt(6)
    v_mfma_f32_32x32x16_bf16 v[8:23], v[160:163], v[132:135], v[8:23]
    s_waitcnt lgkmcnt(4)
    v_mfma_f32_32x32x16_bf16 v[24:39], v[164:167], v[132:135], v[24:39]
    v_mov_b32 v1, v6
    s_lshl_b32 s42, s40, 4
    s_add_u32 s43, s42, s41
    s_mul_i32 s43, s43, 12
    s_add_u32 s43, s43, s28
    s_lshl_b32 s43, s43, 12
    s_add_u32 s36, s43, 33554432
    s_add_u32 s43, s42, s55
    s_mul_i32 s43, s43, 12
    s_add_u32 s43, s43, s28
    s_lshl_b32 s43, s43, 2
    s_add_u32 s43, s43, s54
    s_lshl_b32 s43, s43, 10
    s_add_u32 s58, s43, 33554432
    s_waitcnt lgkmcnt(0)
    s_barrier
    ds_read_b128 v[72:75], v1 offset:0
    ds_read_b128 v[76:79], v1 offset:1024
    ds_read_b128 v[80:83], v1 offset:2048
    ds_read_b128 v[84:87], v1 offset:3072
    ds_read_b128 v[88:91], v1 offset:4096
    ds_read_b128 v[92:95], v1 offset:5120
    ds_read_b128 v[96:99], v1 offset:6144
    ds_read_b128 v[100:103], v1 offset:7168
    s_waitcnt lgkmcnt(6)
    v_add_f32 v8, v8, v72
    v_add_f32 v9, v9, v73
    v_add_f32 v10, v10, v74
    v_add_f32 v11, v11, v75
    v_add_f32 v12, v12, v76
    v_add_f32 v13, v13, v77
    v_add_f32 v14, v14, v78
    v_add_f32 v15, v15, v79
    s_cmp_eq_u32 s54, 0
    s_cbranch_scc1 of_119
    v_cvt_pk_bf16_f32 v136, v8, v9
    v_cvt_pk_bf16_f32 v137, v10, v11
    v_cvt_pk_bf16_f32 v138, v12, v13
    v_cvt_pk_bf16_f32 v139, v14, v15
    buffer_store_dwordx4 v[136:139], v4, s[24:27], s36 offen offset:0 sc1
    s_branch of_120
of_119:
    v_mov_b32 v40, v8
    v_mov_b32 v41, v9
    v_mov_b32 v42, v10
    v_mov_b32 v43, v11
    v_mov_b32 v44, v12
    v_mov_b32 v45, v13
    v_mov_b32 v46, v14
    v_mov_b32 v47, v15
of_120:
    s_waitcnt lgkmcnt(4)
    v_add_f32 v16, v16, v80
    v_add_f32 v17, v17, v81
    v_add_f32 v18, v18, v82
    v_add_f32 v19, v19, v83
    v_add_f32 v20, v20, v84
    v_add_f32 v21, v21, v85
    v_add_f32 v22, v22, v86
    v_add_f32 v23, v23, v87
    s_cmp_eq_u32 s54, 1
    s_cbranch_scc1 of_121
    v_cvt_pk_bf16_f32 v140, v16, v17
    v_cvt_pk_bf16_f32 v141, v18, v19
    v_cvt_pk_bf16_f32 v142, v20, v21
    v_cvt_pk_bf16_f32 v143, v22, v23
    buffer_store_dwordx4 v[140:143], v4, s[24:27], s36 offen offset:1024 sc1
    s_branch of_122
of_121:
    v_mov_b32 v40, v16
    v_mov_b32 v41, v17
    v_mov_b32 v42, v18
    v_mov_b32 v43, v19
    v_mov_b32 v44, v20
    v_mov_b32 v45, v21
    v_mov_b32 v46, v22
    v_mov_b32 v47, v23
of_122:
    s_waitcnt lgkmcnt(2)
    v_add_f32 v24, v24, v88
    v_add_f32 v25, v25, v89
    v_add_f32 v26, v26, v90
    v_add_f32 v27, v27, v91
    v_add_f32 v28, v28, v92
    v_add_f32 v29, v29, v93
    v_add_f32 v30, v30, v94
    v_add_f32 v31, v31, v95
    s_cmp_eq_u32 s54, 2
    s_cbranch_scc1 of_123
    v_cvt_pk_bf16_f32 v144, v24, v25
    v_cvt_pk_bf16_f32 v145, v26, v27
    v_cvt_pk_bf16_f32 v146, v28, v29
    v_cvt_pk_bf16_f32 v147, v30, v31
    buffer_store_dwordx4 v[144:147], v4, s[24:27], s36 offen offset:2048 sc1
    s_branch of_124
of_123:
    v_mov_b32 v40, v24
    v_mov_b32 v41, v25
    v_mov_b32 v42, v26
    v_mov_b32 v43, v27
    v_mov_b32 v44, v28
    v_mov_b32 v45, v29
    v_mov_b32 v46, v30
    v_mov_b32 v47, v31
of_124:
    s_waitcnt lgkmcnt(0)
    v_add_f32 v32, v32, v96
    v_add_f32 v33, v33, v97
    v_add_f32 v34, v34, v98
    v_add_f32 v35, v35, v99
    v_add_f32 v36, v36, v100
    v_add_f32 v37, v37, v101
    v_add_f32 v38, v38, v102
    v_add_f32 v39, v39, v103
    s_cmp_eq_u32 s54, 3
    s_cbranch_scc1 of_125
    v_cvt_pk_bf16_f32 v148, v32, v33
    v_cvt_pk_bf16_f32 v149, v34, v35
    v_cvt_pk_bf16_f32 v150, v36, v37
    v_cvt_pk_bf16_f32 v151, v38, v39
    buffer_store_dwordx4 v[148:151], v4, s[24:27], s36 offen offset:3072 sc1
    s_branch of_126
of_125:
    v_mov_b32 v40, v32
    v_mov_b32 v41, v33
    v_mov_b32 v42, v34
    v_mov_b32 v43, v35
    v_mov_b32 v44, v36
    v_mov_b32 v45, v37
    v_mov_b32 v46, v38
    v_mov_b32 v47, v39
of_126:
    v_and_b32 v0, 31, v7
    v_lshlrev_b32 v0, 10, v0
    v_lshrrev_b32 v1, 5, v7
    v_lshl_add_u32 v0, v1, 4, v0
    s_mul_i32 s46, s40, 6
    s_add_u32 s46, s46, s30
    s_lshl_b32 s46, s46, 15
    s_lshl_b32 s42, s55, 8
    s_add_u32 s46, s46, s42
    s_lshl_b32 s42, s29, 7
    s_add_u32 s46, s46, s42
    s_lshl_b32 s42, s54, 5
    s_add_u32 s46, s46, s42
    s_add_u32 s42, s54, 1
    s_and_b32 s42, s42, 3
    s_mul_i32 s42, s42, 196608
    s_add_u32 s51, s58, s42
    s_add_u32 s42, s54, 2
    s_and_b32 s42, s42, 3
    s_mul_i32 s42, s42, 196608
    s_add_u32 s52, s58, s42
    s_add_u32 s42, s54, 3
    s_and_b32 s42, s42, 3
    s_mul_i32 s42, s42, 196608
    s_add_u32 s53, s58, s42
    s_waitcnt vmcnt(0)
    s_barrier
    s_cmp_lg_u32 s28, 4
    s_cbranch_scc1 sig_127
    s_lshl_b32 s42, s40, 11
    s_add_u32 s42, s42, 67174400
    s_lshl_b32 s43, s41, 7
    s_add_u32 s43, s43, s42
    v_mov_b32 v6, s43
    v_mov_b32 v104, 1
    s_mov_b64 exec, 1
    global_store_dword v6, v104, s[98:99] sc1
    s_mov_b64 exec, -1
    s_lshl_b32 s43, s55, 7
    s_add_u32 s42, s42, s43
    v_lshlrev_b32 v6, 9, v7
    v_add_u32 v6, s42, v6
poll_129:
    s_mov_b64 exec, 0xf
    global_load_dword v104, v6, s[98:99] sc1
    s_sub_u32 s57, s57, 1
    s_waitcnt vmcnt(0)
    v_cmp_ne_u32 vcc, 1, v104
    s_mov_b64 exec, -1
    s_cbranch_scc1 sig_127
    s_cbranch_vccz sig_127
    s_sleep 2
    s_branch poll_129
sig_127:
    s_max_i32 s57, s57, 0
    s_barrier
    buffer_load_dwordx4 v[76:79], v4, s[24:27], s51 offen sc1
    buffer_load_dwordx4 v[80:83], v4, s[24:27], s52 offen sc1
    buffer_load_dwordx4 v[84:87], v4, s[24:27], s53 offen sc1
    s_mov_b32 s42, 0xffff0000
    s_waitcnt vmcnt(2)
    v_lshlrev_b32 v48, 16, v76
    v_and_b32 v49, s42, v76
    v_add_f32 v40, v40, v48
    v_add_f32 v41, v41, v49
    v_lshlrev_b32 v48, 16, v77
    v_and_b32 v49, s42, v77
    v_add_f32 v42, v42, v48
    v_add_f32 v43, v43, v49
    v_lshlrev_b32 v48, 16, v78
    v_and_b32 v49, s42, v78
    v_add_f32 v44, v44, v48
    v_add_f32 v45, v45, v49
    v_lshlrev_b32 v48, 16, v79
    v_and_b32 v49, s42, v79
    v_add_f32 v46, v46, v48
    v_add_f32 v47, v47, v49
    s_waitcnt vmcnt(1)
    v_lshlrev_b32 v48, 16, v80
    v_and_b32 v49, s42, v80
    v_add_f32 v40, v40, v48
    v_add_f32 v41, v41, v49
    v_lshlrev_b32 v48, 16, v81
    v_and_b32 v49, s42, v81
    v_add_f32 v42, v42, v48
    v_add_f32 v43, v43, v49
    v_lshlrev_b32 v48, 16, v82
    v_and_b32 v49, s42, v82
    v_add_f32 v44, v44, v48
    v_add_f32 v45, v45, v49
    v_lshlrev_b32 v48, 16, v83
    v_and_b32 v49, s42, v83
    v_add_f32 v46, v46, v48
    v_add_f32 v47, v47, v49
    s_waitcnt vmcnt(0)
    v_lshlrev_b32 v48, 16, v84
    v_and_b32 v49, s42, v84
    v_add_f32 v40, v40, v48
    v_add_f32 v41, v41, v49
    v_lshlrev_b32 v48, 16, v85
    v_and_b32 v49, s42, v85
    v_add_f32 v42, v42, v48
    v_add_f32 v43, v43, v49
    v_lshlrev_b32 v48, 16, v86
    v_and_b32 v49, s42, v86
    v_add_f32 v44, v44, v48
    v_add_f32 v45, v45, v49
    v_lshlrev_b32 v48, 16, v87
    v_and_b32 v49, s42, v87
    v_add_f32 v46, v46, v48
    v_add_f32 v47, v47, v49
    v_cvt_pk_bf16_f32 v136, v40, v41
    v_cvt_pk_bf16_f32 v137, v42, v43
    v_cvt_pk_bf16_f32 v138, v44, v45
    v_cvt_pk_bf16_f32 v139, v46, v47
    buffer_store_dwordx4 v[136:139], v0, s[12:15], s46 offen
standalone__mha_block_cached__near_ridge_kernel_end:
    s_endpgm
standalone__mha_block_cached__near_ridge_kernel_rescale0:
    v_mov_b32 v4, v3
    s_nop 1
    v_permlane32_swap_b32 v3, v4
    s_nop 1
    v_max_f32 v3, v3, v4
    v_max_f32 v3, 0, v3
    v_exp_f32 v4, -v3
    v_sub_f32 v120, v120, v3
    v_sub_f32 v121, v121, v3
    v_sub_f32 v122, v122, v3
    v_sub_f32 v123, v123, v3
    v_sub_f32 v124, v124, v3
    v_sub_f32 v125, v125, v3
    v_sub_f32 v126, v126, v3
    v_sub_f32 v127, v127, v3
    v_sub_f32 v128, v128, v3
    v_sub_f32 v129, v129, v3
    v_sub_f32 v130, v130, v3
    v_sub_f32 v131, v131, v3
    v_sub_f32 v132, v132, v3
    v_sub_f32 v133, v133, v3
    v_sub_f32 v134, v134, v3
    v_sub_f32 v135, v135, v3
    v_sub_f32 v104, v104, v3
    v_sub_f32 v105, v105, v3
    v_sub_f32 v106, v106, v3
    v_sub_f32 v107, v107, v3
    v_sub_f32 v108, v108, v3
    v_sub_f32 v109, v109, v3
    v_sub_f32 v110, v110, v3
    v_sub_f32 v111, v111, v3
    v_sub_f32 v112, v112, v3
    v_sub_f32 v113, v113, v3
    v_sub_f32 v114, v114, v3
    v_sub_f32 v115, v115, v3
    v_sub_f32 v116, v116, v3
    v_sub_f32 v117, v117, v3
    v_sub_f32 v118, v118, v3
    v_sub_f32 v119, v119, v3
    v_mul_f32 v8, v4, v8
    v_mul_f32 v9, v4, v9
    v_mul_f32 v10, v4, v10
    v_mul_f32 v11, v4, v11
    v_mul_f32 v12, v4, v12
    v_mul_f32 v13, v4, v13
    v_mul_f32 v14, v4, v14
    v_mul_f32 v15, v4, v15
    v_mul_f32 v16, v4, v16
    v_mul_f32 v17, v4, v17
    v_mul_f32 v18, v4, v18
    v_mul_f32 v19, v4, v19
    v_mul_f32 v20, v4, v20
    v_mul_f32 v21, v4, v21
    v_mul_f32 v22, v4, v22
    v_mul_f32 v23, v4, v23
    v_mul_f32 v24, v4, v24
    v_mul_f32 v25, v4, v25
    v_mul_f32 v26, v4, v26
    v_mul_f32 v27, v4, v27
    v_mul_f32 v28, v4, v28
    v_mul_f32 v29, v4, v29
    v_mul_f32 v30, v4, v30
    v_mul_f32 v31, v4, v31
    v_mul_f32 v32, v4, v32
    v_mul_f32 v33, v4, v33
    v_mul_f32 v34, v4, v34
    v_mul_f32 v35, v4, v35
    v_mul_f32 v36, v4, v36
    v_mul_f32 v37, v4, v37
    v_mul_f32 v38, v4, v38
    v_mul_f32 v39, v4, v39
    v_mul_f32 v40, v4, v40
    v_mul_f32 v41, v4, v41
    v_mul_f32 v42, v4, v42
    v_mul_f32 v43, v4, v43
    v_mul_f32 v44, v4, v44
    v_mul_f32 v45, v4, v45
    v_mul_f32 v46, v4, v46
    v_mul_f32 v47, v4, v47
    v_mul_f32 v48, v4, v48
    v_mul_f32 v49, v4, v49
    v_mul_f32 v50, v4, v50
    v_mul_f32 v51, v4, v51
    v_mul_f32 v52, v4, v52
    v_mul_f32 v53, v4, v53
    v_mul_f32 v54, v4, v54
    v_mul_f32 v55, v4, v55
    v_mul_f32 v56, v4, v56
    v_mul_f32 v57, v4, v57
    v_mul_f32 v58, v4, v58
    v_mul_f32 v59, v4, v59
    v_mul_f32 v60, v4, v60
    v_mul_f32 v61, v4, v61
    v_mul_f32 v62, v4, v62
    v_mul_f32 v63, v4, v63
    v_mul_f32 v64, v4, v64
    v_mul_f32 v65, v4, v65
    v_mul_f32 v66, v4, v66
    v_mul_f32 v67, v4, v67
    v_mul_f32 v68, v4, v68
    v_mul_f32 v69, v4, v69
    v_mul_f32 v70, v4, v70
    v_mul_f32 v71, v4, v71
    v_mul_f32 v2, v4, v2
    s_nop 1
    s_setpc_b64 s[32:33]
standalone__mha_block_cached__near_ridge_kernel_rescale1:
    v_mov_b32 v4, v3
    s_nop 1
    v_permlane32_swap_b32 v3, v4
    s_nop 1
    v_max_f32 v3, v3, v4
    v_max_f32 v3, 0, v3
    v_exp_f32 v4, -v3
    v_sub_f32 v136, v136, v3
    v_sub_f32 v137, v137, v3
    v_sub_f32 v138, v138, v3
    v_sub_f32 v139, v139, v3
    v_sub_f32 v140, v140, v3
    v_sub_f32 v141, v141, v3
    v_sub_f32 v142, v142, v3
    v_sub_f32 v143, v143, v3
    v_sub_f32 v144, v144, v3
    v_sub_f32 v145, v145, v3
    v_sub_f32 v146, v146, v3
    v_sub_f32 v147, v147, v3
    v_sub_f32 v148, v148, v3
    v_sub_f32 v149, v149, v3
    v_sub_f32 v150, v150, v3
    v_sub_f32 v151, v151, v3
    v_sub_f32 v104, v104, v3
    v_sub_f32 v105, v105, v3
    v_sub_f32 v106, v106, v3
    v_sub_f32 v107, v107, v3
    v_sub_f32 v108, v108, v3
    v_sub_f32 v109, v109, v3
    v_sub_f32 v110, v110, v3
    v_sub_f32 v111, v111, v3
    v_sub_f32 v112, v112, v3
    v_sub_f32 v113, v113, v3
    v_sub_f32 v114, v114, v3
    v_sub_f32 v115, v115, v3
    v_sub_f32 v116, v116, v3
    v_sub_f32 v117, v117, v3
    v_sub_f32 v118, v118, v3
    v_sub_f32 v119, v119, v3
    v_mul_f32 v8, v4, v8
    v_mul_f32 v9, v4, v9
    v_mul_f32 v10, v4, v10
    v_mul_f32 v11, v4, v11
    v_mul_f32 v12, v4, v12
    v_mul_f32 v13, v4, v13
    v_mul_f32 v14, v4, v14
    v_mul_f32 v15, v4, v15
    v_mul_f32 v16, v4, v16
    v_mul_f32 v17, v4, v17
    v_mul_f32 v18, v4, v18
    v_mul_f32 v19, v4, v19
    v_mul_f32 v20, v4, v20
    v_mul_f32 v21, v4, v21
    v_mul_f32 v22, v4, v22
    v_mul_f32 v23, v4, v23
    v_mul_f32 v24, v4, v24
    v_mul_f32 v25, v4, v25
    v_mul_f32 v26, v4, v26
    v_mul_f32 v27, v4, v27
    v_mul_f32 v28, v4, v28
    v_mul_f32 v29, v4, v29
    v_mul_f32 v30, v4, v30
    v_mul_f32 v31, v4, v31
    v_mul_f32 v32, v4, v32
    v_mul_f32 v33, v4, v33
    v_mul_f32 v34, v4, v34
    v_mul_f32 v35, v4, v35
    v_mul_f32 v36, v4, v36
    v_mul_f32 v37, v4, v37
    v_mul_f32 v38, v4, v38
    v_mul_f32 v39, v4, v39
    v_mul_f32 v40, v4, v40
    v_mul_f32 v41, v4, v41
    v_mul_f32 v42, v4, v42
    v_mul_f32 v43, v4, v43
    v_mul_f32 v44, v4, v44
    v_mul_f32 v45, v4, v45
    v_mul_f32 v46, v4, v46
    v_mul_f32 v47, v4, v47
    v_mul_f32 v48, v4, v48
    v_mul_f32 v49, v4, v49
    v_mul_f32 v50, v4, v50
    v_mul_f32 v51, v4, v51
    v_mul_f32 v52, v4, v52
    v_mul_f32 v53, v4, v53
    v_mul_f32 v54, v4, v54
    v_mul_f32 v55, v4, v55
    v_mul_f32 v56, v4, v56
    v_mul_f32 v57, v4, v57
    v_mul_f32 v58, v4, v58
    v_mul_f32 v59, v4, v59
    v_mul_f32 v60, v4, v60
    v_mul_f32 v61, v4, v61
    v_mul_f32 v62, v4, v62
    v_mul_f32 v63, v4, v63
    v_mul_f32 v64, v4, v64
    v_mul_f32 v65, v4, v65
    v_mul_f32 v66, v4, v66
    v_mul_f32 v67, v4, v67
    v_mul_f32 v68, v4, v68
    v_mul_f32 v69, v4, v69
    v_mul_f32 v70, v4, v70
    v_mul_f32 v71, v4, v71
    v_mul_f32 v2, v4, v2
    s_nop 1
    s_setpc_b64 s[32:33]
.section .rodata,"a"
.p2align 6
.amdhsa_kernel standalone__mha_block_cached__near_ridge_kernel
  .amdhsa_next_free_vgpr 168
  .amdhsa_next_free_sgpr 100
  .amdhsa_accum_offset 168
  .amdhsa_group_segment_fixed_size 0
  .amdhsa_kernarg_size 64
  .amdhsa_user_sgpr_count 2
  .amdhsa_user_sgpr_kernarg_segment_ptr 1
  .amdhsa_system_sgpr_workgroup_id_x 1
  .amdhsa_float_denorm_mode_32 3
  .amdhsa_float_denorm_mode_16_64 3
.end_amdhsa_kernel
```
